```python
import torch

def _softmax(x, axis=-1):
    return torch.softmax(x, dim=axis)
def _gelu(x):
    return torch.nn.functional.gelu(x, approximate="tanh")
def _silu(x):
    return torch.nn.functional.silu(x)
def _sigmoid(x):
    return torch.sigmoid(x)
def _layernorm(x, axis=-1, eps=1e-5):
    m = x.mean(dim=axis, keepdim=True)
    v = x.var(dim=axis, keepdim=True, unbiased=False)
    return (x - m) / torch.sqrt(v + eps)
def _scatter_add(tgt, idx, src, axis=0):
    return tgt.clone().index_add_(axis, idx, src)
def _segment_sum(src, seg, n):
    out = torch.zeros((n,) + src.shape[1:], dtype=src.dtype)
    return out.index_add_(0, seg, src)
def _pad(x, pw):
    flat = tuple(v for pair in reversed(pw) for v in pair)
    return torch.nn.functional.pad(x, flat)

kernel_name = 'sequential_preLN__ssm_conv_s4__geglu_ffn__prompt'

def setup_inputs():

    _w = (lambda a: (lambda t: t.to(torch.bfloat16) if t.is_floating_point() else t)(torch.as_tensor(a)))
    def _A_setup():
        B, L, D, N = 1, 2048, 448, 256
        A_re = -(lambda _x: torch.exp(torch.as_tensor(_x)))((lambda *s: torch.randn(*s, dtype=torch.bfloat16) * 3.2)(D, N))
        A_im = torch.pi * (lambda *s: torch.randn(*s, dtype=torch.bfloat16) * 0.05)(D, N)
        B_re = (lambda *s: torch.randn(*s, dtype=torch.bfloat16) * 0.05)(D, N)
        B_im = (lambda *s: torch.randn(*s, dtype=torch.bfloat16) * 0.05)(D, N)
        C_re = (lambda *s: torch.randn(*s, dtype=torch.bfloat16) * 0.05)(D, N)
        C_im = (lambda *s: torch.randn(*s, dtype=torch.bfloat16) * 0.05)(D, N)
        log_dt = (lambda *s: torch.randn(*s, dtype=torch.bfloat16) * 0.05)(D) * 0.5 - 4.0
        Dskip = (lambda *s: torch.randn(*s, dtype=torch.bfloat16) * 0.05)(D)
        return {
            "u": _w((lambda *s: torch.randn(*s, dtype=torch.bfloat16) * 0.05)(B, L, D)),
            "A_re": _w(A_re),
            "A_im": _w(A_im),
            "B_re": _w(B_re),
            "B_im": _w(B_im),
            "C_re": _w(C_re),
            "C_im": _w(C_im),
            "log_dt": _w(log_dt),
            "Dskip": _w(Dskip),
        }
    _A_in = _A_setup()

    def _B_setup():
        B, S, D, F = 1, 2048, 448, 1792
        return {
            "x": _w((lambda *s: torch.randn(*s, dtype=torch.bfloat16) * 0.05)(B, S, D)),
            "w_gate": _w((lambda *s: torch.randn(*s, dtype=torch.bfloat16) * 0.05)(D, F)),
            "w_up": _w((lambda *s: torch.randn(*s, dtype=torch.bfloat16) * 0.05)(D, F)),
            "w_down": _w((lambda *s: torch.randn(*s, dtype=torch.bfloat16) * 0.05)(F, D)),
        }
    _B_in = _B_setup()

    return {
        "A_u": _A_in["u"],
        "A_A_re": _A_in["A_re"],
        "A_A_im": _A_in["A_im"],
        "A_B_re": _A_in["B_re"],
        "A_B_im": _A_in["B_im"],
        "A_C_re": _A_in["C_re"],
        "A_C_im": _A_in["C_im"],
        "A_log_dt": _A_in["log_dt"],
        "A_Dskip": _A_in["Dskip"],
        "B_x": _B_in["x"],
        "B_w_gate": _B_in["w_gate"],
        "B_w_up": _B_in["w_up"],
        "B_w_down": _B_in["w_down"],
    }

def reference(A_u, A_A_re, A_A_im, A_B_re, A_B_im, A_C_re, A_C_im, A_log_dt, A_Dskip, B_x, B_w_gate, B_w_up, B_w_down):
    def _A_ref(u, A_re, A_im, B_re, B_im, C_re, C_im, log_dt, Dskip):
        Bsz, L, D = u.shape
        dt = torch.exp(log_dt)[:, None]
        A = A_re + 1j * A_im
        Bc = B_re + 1j * B_im
        Cc = C_re + 1j * C_im
        logdA = dt * A
        dB = dt * Bc
        l = (lambda x, dt: x.to(dt))(torch.arange(L), A_re.dtype)
        P = torch.exp(logdA[:, :, None] * l[None, None, :])
        K = torch.einsum("dn,dnl,dn->dl", Cc, P, dB).real
        L2 = 2 * L
        Kp = _pad(K, ((0, 0), (0, L)))
        up = (lambda x, *d: x.permute(*d))(u, 0, 2, 1)
        up = _pad(up, ((0, 0), (0, 0), (0, L)))
        Kf = (lambda x, axes=(-2,-1): torch.fft.rfft2(x.float(), dim=axes))(Kp[:, None, :], axes=(-2, -1))
        Uf = (lambda x, axes=(-2,-1): torch.fft.rfft2(x.float(), dim=axes))(up[:, :, None, :], axes=(-2, -1))
        Yf = Uf * Kf[None, :, :, :]
        y = (lambda x, s, axes=(-2,-1): torch.fft.irfft2(x, s=s, dim=axes).to(torch.bfloat16))(Yf, (1, L2), axes=(-2, -1))[:, :, 0, :L]
        y = (lambda x, *d: x.permute(*d))(y, 0, 2, 1) + u * Dskip[None, None, :]
        return y

    def _B_ref(x, w_gate, w_up, w_down):
        return (_gelu(x @ w_gate) * (x @ w_up)) @ w_down

    x = A_u
    h = x + _A_ref(_layernorm(x, axis=-1), A_A_re, A_A_im, A_B_re, A_B_im, A_C_re, A_C_im, A_log_dt, A_Dskip)
    h2 = h + _B_ref(_layernorm(h, axis=-1), B_w_gate, B_w_up, B_w_down)
    return h2
```

```asm
; @launch kernel=k1_kernel grid=(512,1,1) block=(256,1,1) lds=75328
; @launch kernel=k2_kernel grid=(504,1,1) block=(256,1,1) lds=47616
; @launch kernel=k3_kernel grid=(240,1,1) block=(512,1,1) lds=155648
; @launch kernel=k4_kernel grid=(224,1,1) block=(512,1,1) lds=139264
.amdgcn_target "amdgcn-amd-amdhsa--gfx950"
.text
.globl k1_kernel
.p2align 8
.type k1_kernel,@function
k1_kernel:
    s_cmp_ge_u32 s2, 512
    s_cbranch_scc1 K1_END
    s_cmp_ge_u32 s2, 64
    s_cbranch_scc1 K1_KGEN
    s_setprio 2
    s_load_dwordx2 s[4:5], s[0:1], 0
    s_load_dwordx2 s[6:7], s[0:1], 120
    v_lshrrev_b32 v1, 6, v0
    v_and_b32 v2, 63, v0
    s_nop 0
    v_readfirstlane_b32 s3, v1
    s_lshl_b32 s40, s2, 2
    s_nop 2
    s_add_u32 s40, s40, s3
    s_lshl_b32 s40, s40, 3
    s_mul_i32 s41, s40, 896
    v_cmp_gt_u32 vcc, 56, v2
    v_lshlrev_b32 v3, 4, v2
    v_mov_b32 v4, 0x40000000
    v_cndmask_b32 v3, v4, v3, vcc
    s_mov_b64 s[44:45], vcc
    s_waitcnt lgkmcnt(0)
    s_mov_b32 s8, s4
    s_mov_b32 s9, s5
    s_mov_b32 s10, 1835008
    s_mov_b32 s11, 0x00020000
    s_mov_b32 s12, s6
    s_mov_b32 s13, s7
    s_mov_b32 s14, 1949696
    s_mov_b32 s15, 0x00020000
    s_add_u32 s16, s6, 1949696
    s_addc_u32 s17, s7, 0
    s_mov_b32 s18, 1949696
    s_mov_b32 s19, 0x00020000
    buffer_load_dwordx4 v[8:11], v3, s[8:11], s41 offen
    s_add_u32 s41, s41, 896
    buffer_load_dwordx4 v[12:15], v3, s[8:11], s41 offen
    s_add_u32 s41, s41, 896
    buffer_load_dwordx4 v[16:19], v3, s[8:11], s41 offen
    s_add_u32 s41, s41, 896
    buffer_load_dwordx4 v[20:23], v3, s[8:11], s41 offen
    s_add_u32 s41, s41, 896
    buffer_load_dwordx4 v[24:27], v3, s[8:11], s41 offen
    s_add_u32 s41, s41, 896
    buffer_load_dwordx4 v[28:31], v3, s[8:11], s41 offen
    s_add_u32 s41, s41, 896
    buffer_load_dwordx4 v[32:35], v3, s[8:11], s41 offen
    s_add_u32 s41, s41, 896
    buffer_load_dwordx4 v[36:39], v3, s[8:11], s41 offen
    v_mul_u32_u24 v5, 640, v2
    v_mov_b32 v4, 71680
    s_lshl_b32 s46, s3, 4
    v_add_u32 v6, s46, v5
    v_add_u32 v6, 35840, v6
    s_sub_u32 s46, 48, s46
    v_add_u32 v5, s46, v5
    v_cndmask_b32 v5, v4, v5, vcc
    v_cndmask_b32 v6, v4, v6, vcc
    s_mov_b32 s48, 0x05040100
    s_mov_b32 s49, 0x07060302
    s_waitcnt vmcnt(7)
    v_lshlrev_b32 v40, 16, v8
    v_and_b32 v41, 0xffff0000, v8
    v_lshlrev_b32 v42, 16, v9
    v_and_b32 v43, 0xffff0000, v9
    v_lshlrev_b32 v44, 16, v10
    v_and_b32 v45, 0xffff0000, v10
    v_lshlrev_b32 v46, 16, v11
    v_and_b32 v47, 0xffff0000, v11
    v_pk_add_f32 v[104:105], v[40:41], v[42:43]
    v_pk_add_f32 v[106:107], v[44:45], v[46:47]
    v_pk_mul_f32 v[108:109], v[40:41], v[40:41]
    v_pk_mul_f32 v[110:111], v[44:45], v[44:45]
    v_pk_add_f32 v[104:105], v[104:105], v[106:107]
    v_pk_fma_f32 v[108:109], v[42:43], v[42:43], v[108:109]
    v_pk_fma_f32 v[110:111], v[46:47], v[46:47], v[110:111]
    v_add_f32 v120, v104, v105
    v_pk_add_f32 v[108:109], v[108:109], v[110:111]
    v_add_f32 v128, v108, v109
    s_waitcnt vmcnt(6)
    v_lshlrev_b32 v48, 16, v12
    v_and_b32 v49, 0xffff0000, v12
    v_lshlrev_b32 v50, 16, v13
    v_and_b32 v51, 0xffff0000, v13
    v_lshlrev_b32 v52, 16, v14
    v_and_b32 v53, 0xffff0000, v14
    v_lshlrev_b32 v54, 16, v15
    v_and_b32 v55, 0xffff0000, v15
    v_pk_add_f32 v[112:113], v[48:49], v[50:51]
    v_pk_add_f32 v[114:115], v[52:53], v[54:55]
    v_pk_mul_f32 v[116:117], v[48:49], v[48:49]
    v_pk_mul_f32 v[118:119], v[52:53], v[52:53]
    v_pk_add_f32 v[112:113], v[112:113], v[114:115]
    v_pk_fma_f32 v[116:117], v[50:51], v[50:51], v[116:117]
    v_pk_fma_f32 v[118:119], v[54:55], v[54:55], v[118:119]
    v_add_f32 v121, v112, v113
    v_pk_add_f32 v[116:117], v[116:117], v[118:119]
    v_add_f32 v129, v116, v117
    s_waitcnt vmcnt(5)
    v_lshlrev_b32 v56, 16, v16
    v_and_b32 v57, 0xffff0000, v16
    v_lshlrev_b32 v58, 16, v17
    v_and_b32 v59, 0xffff0000, v17
    v_lshlrev_b32 v60, 16, v18
    v_and_b32 v61, 0xffff0000, v18
    v_lshlrev_b32 v62, 16, v19
    v_and_b32 v63, 0xffff0000, v19
    v_pk_add_f32 v[104:105], v[56:57], v[58:59]
    v_pk_add_f32 v[106:107], v[60:61], v[62:63]
    v_pk_mul_f32 v[108:109], v[56:57], v[56:57]
    v_pk_mul_f32 v[110:111], v[60:61], v[60:61]
    v_pk_add_f32 v[104:105], v[104:105], v[106:107]
    v_pk_fma_f32 v[108:109], v[58:59], v[58:59], v[108:109]
    v_pk_fma_f32 v[110:111], v[62:63], v[62:63], v[110:111]
    v_add_f32 v122, v104, v105
    v_pk_add_f32 v[108:109], v[108:109], v[110:111]
    v_add_f32 v130, v108, v109
    s_waitcnt vmcnt(4)
    v_lshlrev_b32 v64, 16, v20
    v_and_b32 v65, 0xffff0000, v20
    v_lshlrev_b32 v66, 16, v21
    v_and_b32 v67, 0xffff0000, v21
    v_lshlrev_b32 v68, 16, v22
    v_and_b32 v69, 0xffff0000, v22
    v_lshlrev_b32 v70, 16, v23
    v_and_b32 v71, 0xffff0000, v23
    v_pk_add_f32 v[112:113], v[64:65], v[66:67]
    v_pk_add_f32 v[114:115], v[68:69], v[70:71]
    v_pk_mul_f32 v[116:117], v[64:65], v[64:65]
    v_pk_mul_f32 v[118:119], v[68:69], v[68:69]
    v_pk_add_f32 v[112:113], v[112:113], v[114:115]
    v_pk_fma_f32 v[116:117], v[66:67], v[66:67], v[116:117]
    v_pk_fma_f32 v[118:119], v[70:71], v[70:71], v[118:119]
    v_add_f32 v123, v112, v113
    v_pk_add_f32 v[116:117], v[116:117], v[118:119]
    v_add_f32 v131, v116, v117
    s_waitcnt vmcnt(3)
    v_lshlrev_b32 v72, 16, v24
    v_and_b32 v73, 0xffff0000, v24
    v_lshlrev_b32 v74, 16, v25
    v_and_b32 v75, 0xffff0000, v25
    v_lshlrev_b32 v76, 16, v26
    v_and_b32 v77, 0xffff0000, v26
    v_lshlrev_b32 v78, 16, v27
    v_and_b32 v79, 0xffff0000, v27
    v_pk_add_f32 v[104:105], v[72:73], v[74:75]
    v_pk_add_f32 v[106:107], v[76:77], v[78:79]
    v_pk_mul_f32 v[108:109], v[72:73], v[72:73]
    v_pk_mul_f32 v[110:111], v[76:77], v[76:77]
    v_pk_add_f32 v[104:105], v[104:105], v[106:107]
    v_pk_fma_f32 v[108:109], v[74:75], v[74:75], v[108:109]
    v_pk_fma_f32 v[110:111], v[78:79], v[78:79], v[110:111]
    v_add_f32 v124, v104, v105
    v_pk_add_f32 v[108:109], v[108:109], v[110:111]
    v_add_f32 v132, v108, v109
    s_waitcnt vmcnt(2)
    v_lshlrev_b32 v80, 16, v28
    v_and_b32 v81, 0xffff0000, v28
    v_lshlrev_b32 v82, 16, v29
    v_and_b32 v83, 0xffff0000, v29
    v_lshlrev_b32 v84, 16, v30
    v_and_b32 v85, 0xffff0000, v30
    v_lshlrev_b32 v86, 16, v31
    v_and_b32 v87, 0xffff0000, v31
    v_pk_add_f32 v[112:113], v[80:81], v[82:83]
    v_pk_add_f32 v[114:115], v[84:85], v[86:87]
    v_pk_mul_f32 v[116:117], v[80:81], v[80:81]
    v_pk_mul_f32 v[118:119], v[84:85], v[84:85]
    v_pk_add_f32 v[112:113], v[112:113], v[114:115]
    v_pk_fma_f32 v[116:117], v[82:83], v[82:83], v[116:117]
    v_pk_fma_f32 v[118:119], v[86:87], v[86:87], v[118:119]
    v_add_f32 v125, v112, v113
    v_pk_add_f32 v[116:117], v[116:117], v[118:119]
    v_add_f32 v133, v116, v117
    s_waitcnt vmcnt(1)
    v_lshlrev_b32 v88, 16, v32
    v_and_b32 v89, 0xffff0000, v32
    v_lshlrev_b32 v90, 16, v33
    v_and_b32 v91, 0xffff0000, v33
    v_lshlrev_b32 v92, 16, v34
    v_and_b32 v93, 0xffff0000, v34
    v_lshlrev_b32 v94, 16, v35
    v_and_b32 v95, 0xffff0000, v35
    v_pk_add_f32 v[104:105], v[88:89], v[90:91]
    v_pk_add_f32 v[106:107], v[92:93], v[94:95]
    v_pk_mul_f32 v[108:109], v[88:89], v[88:89]
    v_pk_mul_f32 v[110:111], v[92:93], v[92:93]
    v_pk_add_f32 v[104:105], v[104:105], v[106:107]
    v_pk_fma_f32 v[108:109], v[90:91], v[90:91], v[108:109]
    v_pk_fma_f32 v[110:111], v[94:95], v[94:95], v[110:111]
    v_add_f32 v126, v104, v105
    v_pk_add_f32 v[108:109], v[108:109], v[110:111]
    v_add_f32 v134, v108, v109
    s_waitcnt vmcnt(0)
    v_lshlrev_b32 v96, 16, v36
    v_and_b32 v97, 0xffff0000, v36
    v_lshlrev_b32 v98, 16, v37
    v_and_b32 v99, 0xffff0000, v37
    v_lshlrev_b32 v100, 16, v38
    v_and_b32 v101, 0xffff0000, v38
    v_lshlrev_b32 v102, 16, v39
    v_and_b32 v103, 0xffff0000, v39
    v_pk_add_f32 v[112:113], v[96:97], v[98:99]
    v_pk_add_f32 v[114:115], v[100:101], v[102:103]
    v_pk_mul_f32 v[116:117], v[96:97], v[96:97]
    v_pk_mul_f32 v[118:119], v[100:101], v[100:101]
    v_pk_add_f32 v[112:113], v[112:113], v[114:115]
    v_pk_fma_f32 v[116:117], v[98:99], v[98:99], v[116:117]
    v_pk_fma_f32 v[118:119], v[102:103], v[102:103], v[118:119]
    v_add_f32 v127, v112, v113
    v_pk_add_f32 v[116:117], v[116:117], v[118:119]
    v_add_f32 v135, v116, v117
    s_nop 1
    v_add_f32_dpp v120, v120, v120 row_shr:1 row_mask:0xf bank_mask:0xf bound_ctrl:0
    v_add_f32_dpp v121, v121, v121 row_shr:1 row_mask:0xf bank_mask:0xf bound_ctrl:0
    v_add_f32_dpp v122, v122, v122 row_shr:1 row_mask:0xf bank_mask:0xf bound_ctrl:0
    v_add_f32_dpp v123, v123, v123 row_shr:1 row_mask:0xf bank_mask:0xf bound_ctrl:0
    v_add_f32_dpp v124, v124, v124 row_shr:1 row_mask:0xf bank_mask:0xf bound_ctrl:0
    v_add_f32_dpp v125, v125, v125 row_shr:1 row_mask:0xf bank_mask:0xf bound_ctrl:0
    v_add_f32_dpp v126, v126, v126 row_shr:1 row_mask:0xf bank_mask:0xf bound_ctrl:0
    v_add_f32_dpp v127, v127, v127 row_shr:1 row_mask:0xf bank_mask:0xf bound_ctrl:0
    v_add_f32_dpp v128, v128, v128 row_shr:1 row_mask:0xf bank_mask:0xf bound_ctrl:0
    v_add_f32_dpp v129, v129, v129 row_shr:1 row_mask:0xf bank_mask:0xf bound_ctrl:0
    v_add_f32_dpp v130, v130, v130 row_shr:1 row_mask:0xf bank_mask:0xf bound_ctrl:0
    v_add_f32_dpp v131, v131, v131 row_shr:1 row_mask:0xf bank_mask:0xf bound_ctrl:0
    v_add_f32_dpp v132, v132, v132 row_shr:1 row_mask:0xf bank_mask:0xf bound_ctrl:0
    v_add_f32_dpp v133, v133, v133 row_shr:1 row_mask:0xf bank_mask:0xf bound_ctrl:0
    v_add_f32_dpp v134, v134, v134 row_shr:1 row_mask:0xf bank_mask:0xf bound_ctrl:0
    v_add_f32_dpp v135, v135, v135 row_shr:1 row_mask:0xf bank_mask:0xf bound_ctrl:0
    v_add_f32_dpp v120, v120, v120 row_shr:2 row_mask:0xf bank_mask:0xf bound_ctrl:0
    v_add_f32_dpp v121, v121, v121 row_shr:2 row_mask:0xf bank_mask:0xf bound_ctrl:0
    v_add_f32_dpp v122, v122, v122 row_shr:2 row_mask:0xf bank_mask:0xf bound_ctrl:0
    v_add_f32_dpp v123, v123, v123 row_shr:2 row_mask:0xf bank_mask:0xf bound_ctrl:0
    v_add_f32_dpp v124, v124, v124 row_shr:2 row_mask:0xf bank_mask:0xf bound_ctrl:0
    v_add_f32_dpp v125, v125, v125 row_shr:2 row_mask:0xf bank_mask:0xf bound_ctrl:0
    v_add_f32_dpp v126, v126, v126 row_shr:2 row_mask:0xf bank_mask:0xf bound_ctrl:0
    v_add_f32_dpp v127, v127, v127 row_shr:2 row_mask:0xf bank_mask:0xf bound_ctrl:0
    v_add_f32_dpp v128, v128, v128 row_shr:2 row_mask:0xf bank_mask:0xf bound_ctrl:0
    v_add_f32_dpp v129, v129, v129 row_shr:2 row_mask:0xf bank_mask:0xf bound_ctrl:0
    v_add_f32_dpp v130, v130, v130 row_shr:2 row_mask:0xf bank_mask:0xf bound_ctrl:0
    v_add_f32_dpp v131, v131, v131 row_shr:2 row_mask:0xf bank_mask:0xf bound_ctrl:0
    v_add_f32_dpp v132, v132, v132 row_shr:2 row_mask:0xf bank_mask:0xf bound_ctrl:0
    v_add_f32_dpp v133, v133, v133 row_shr:2 row_mask:0xf bank_mask:0xf bound_ctrl:0
    v_add_f32_dpp v134, v134, v134 row_shr:2 row_mask:0xf bank_mask:0xf bound_ctrl:0
    v_add_f32_dpp v135, v135, v135 row_shr:2 row_mask:0xf bank_mask:0xf bound_ctrl:0
    v_add_f32_dpp v120, v120, v120 row_shr:4 row_mask:0xf bank_mask:0xf bound_ctrl:0
    v_add_f32_dpp v121, v121, v121 row_shr:4 row_mask:0xf bank_mask:0xf bound_ctrl:0
    v_add_f32_dpp v122, v122, v122 row_shr:4 row_mask:0xf bank_mask:0xf bound_ctrl:0
    v_add_f32_dpp v123, v123, v123 row_shr:4 row_mask:0xf bank_mask:0xf bound_ctrl:0
    v_add_f32_dpp v124, v124, v124 row_shr:4 row_mask:0xf bank_mask:0xf bound_ctrl:0
    v_add_f32_dpp v125, v125, v125 row_shr:4 row_mask:0xf bank_mask:0xf bound_ctrl:0
    v_add_f32_dpp v126, v126, v126 row_shr:4 row_mask:0xf bank_mask:0xf bound_ctrl:0
    v_add_f32_dpp v127, v127, v127 row_shr:4 row_mask:0xf bank_mask:0xf bound_ctrl:0
    v_add_f32_dpp v128, v128, v128 row_shr:4 row_mask:0xf bank_mask:0xf bound_ctrl:0
    v_add_f32_dpp v129, v129, v129 row_shr:4 row_mask:0xf bank_mask:0xf bound_ctrl:0
    v_add_f32_dpp v130, v130, v130 row_shr:4 row_mask:0xf bank_mask:0xf bound_ctrl:0
    v_add_f32_dpp v131, v131, v131 row_shr:4 row_mask:0xf bank_mask:0xf bound_ctrl:0
    v_add_f32_dpp v132, v132, v132 row_shr:4 row_mask:0xf bank_mask:0xf bound_ctrl:0
    v_add_f32_dpp v133, v133, v133 row_shr:4 row_mask:0xf bank_mask:0xf bound_ctrl:0
    v_add_f32_dpp v134, v134, v134 row_shr:4 row_mask:0xf bank_mask:0xf bound_ctrl:0
    v_add_f32_dpp v135, v135, v135 row_shr:4 row_mask:0xf bank_mask:0xf bound_ctrl:0
    v_add_f32_dpp v120, v120, v120 row_shr:8 row_mask:0xf bank_mask:0xf bound_ctrl:0
    v_add_f32_dpp v121, v121, v121 row_shr:8 row_mask:0xf bank_mask:0xf bound_ctrl:0
    v_add_f32_dpp v122, v122, v122 row_shr:8 row_mask:0xf bank_mask:0xf bound_ctrl:0
    v_add_f32_dpp v123, v123, v123 row_shr:8 row_mask:0xf bank_mask:0xf bound_ctrl:0
    v_add_f32_dpp v124, v124, v124 row_shr:8 row_mask:0xf bank_mask:0xf bound_ctrl:0
    v_add_f32_dpp v125, v125, v125 row_shr:8 row_mask:0xf bank_mask:0xf bound_ctrl:0
    v_add_f32_dpp v126, v126, v126 row_shr:8 row_mask:0xf bank_mask:0xf bound_ctrl:0
    v_add_f32_dpp v127, v127, v127 row_shr:8 row_mask:0xf bank_mask:0xf bound_ctrl:0
    v_add_f32_dpp v128, v128, v128 row_shr:8 row_mask:0xf bank_mask:0xf bound_ctrl:0
    v_add_f32_dpp v129, v129, v129 row_shr:8 row_mask:0xf bank_mask:0xf bound_ctrl:0
    v_add_f32_dpp v130, v130, v130 row_shr:8 row_mask:0xf bank_mask:0xf bound_ctrl:0
    v_add_f32_dpp v131, v131, v131 row_shr:8 row_mask:0xf bank_mask:0xf bound_ctrl:0
    v_add_f32_dpp v132, v132, v132 row_shr:8 row_mask:0xf bank_mask:0xf bound_ctrl:0
    v_add_f32_dpp v133, v133, v133 row_shr:8 row_mask:0xf bank_mask:0xf bound_ctrl:0
    v_add_f32_dpp v134, v134, v134 row_shr:8 row_mask:0xf bank_mask:0xf bound_ctrl:0
    v_add_f32_dpp v135, v135, v135 row_shr:8 row_mask:0xf bank_mask:0xf bound_ctrl:0
    v_add_f32_dpp v120, v120, v120 row_bcast:15 row_mask:0xa bank_mask:0xf
    v_add_f32_dpp v121, v121, v121 row_bcast:15 row_mask:0xa bank_mask:0xf
    v_add_f32_dpp v122, v122, v122 row_bcast:15 row_mask:0xa bank_mask:0xf
    v_add_f32_dpp v123, v123, v123 row_bcast:15 row_mask:0xa bank_mask:0xf
    v_add_f32_dpp v124, v124, v124 row_bcast:15 row_mask:0xa bank_mask:0xf
    v_add_f32_dpp v125, v125, v125 row_bcast:15 row_mask:0xa bank_mask:0xf
    v_add_f32_dpp v126, v126, v126 row_bcast:15 row_mask:0xa bank_mask:0xf
    v_add_f32_dpp v127, v127, v127 row_bcast:15 row_mask:0xa bank_mask:0xf
    v_add_f32_dpp v128, v128, v128 row_bcast:15 row_mask:0xa bank_mask:0xf
    v_add_f32_dpp v129, v129, v129 row_bcast:15 row_mask:0xa bank_mask:0xf
    v_add_f32_dpp v130, v130, v130 row_bcast:15 row_mask:0xa bank_mask:0xf
    v_add_f32_dpp v131, v131, v131 row_bcast:15 row_mask:0xa bank_mask:0xf
    v_add_f32_dpp v132, v132, v132 row_bcast:15 row_mask:0xa bank_mask:0xf
    v_add_f32_dpp v133, v133, v133 row_bcast:15 row_mask:0xa bank_mask:0xf
    v_add_f32_dpp v134, v134, v134 row_bcast:15 row_mask:0xa bank_mask:0xf
    v_add_f32_dpp v135, v135, v135 row_bcast:15 row_mask:0xa bank_mask:0xf
    v_add_f32_dpp v120, v120, v120 row_bcast:31 row_mask:0xc bank_mask:0xf
    v_add_f32_dpp v121, v121, v121 row_bcast:31 row_mask:0xc bank_mask:0xf
    v_add_f32_dpp v122, v122, v122 row_bcast:31 row_mask:0xc bank_mask:0xf
    v_add_f32_dpp v123, v123, v123 row_bcast:31 row_mask:0xc bank_mask:0xf
    v_add_f32_dpp v124, v124, v124 row_bcast:31 row_mask:0xc bank_mask:0xf
    v_add_f32_dpp v125, v125, v125 row_bcast:31 row_mask:0xc bank_mask:0xf
    v_add_f32_dpp v126, v126, v126 row_bcast:31 row_mask:0xc bank_mask:0xf
    v_add_f32_dpp v127, v127, v127 row_bcast:31 row_mask:0xc bank_mask:0xf
    v_add_f32_dpp v128, v128, v128 row_bcast:31 row_mask:0xc bank_mask:0xf
    v_add_f32_dpp v129, v129, v129 row_bcast:31 row_mask:0xc bank_mask:0xf
    v_add_f32_dpp v130, v130, v130 row_bcast:31 row_mask:0xc bank_mask:0xf
    v_add_f32_dpp v131, v131, v131 row_bcast:31 row_mask:0xc bank_mask:0xf
    v_add_f32_dpp v132, v132, v132 row_bcast:31 row_mask:0xc bank_mask:0xf
    v_add_f32_dpp v133, v133, v133 row_bcast:31 row_mask:0xc bank_mask:0xf
    v_add_f32_dpp v134, v134, v134 row_bcast:31 row_mask:0xc bank_mask:0xf
    v_add_f32_dpp v135, v135, v135 row_bcast:31 row_mask:0xc bank_mask:0xf
    s_nop 1
    v_readlane_b32 s60, v120, 63
    v_readlane_b32 s61, v121, 63
    v_readlane_b32 s62, v122, 63
    v_readlane_b32 s63, v123, 63
    v_readlane_b32 s64, v124, 63
    v_readlane_b32 s65, v125, 63
    v_readlane_b32 s66, v126, 63
    v_readlane_b32 s67, v127, 63
    v_readlane_b32 s68, v128, 63
    v_readlane_b32 s69, v129, 63
    v_readlane_b32 s70, v130, 63
    v_readlane_b32 s71, v131, 63
    v_readlane_b32 s72, v132, 63
    v_readlane_b32 s73, v133, 63
    v_readlane_b32 s74, v134, 63
    v_readlane_b32 s75, v135, 63
    s_nop 3
    v_writelane_b32 v117, s60, 0
    v_writelane_b32 v116, s68, 0
    v_writelane_b32 v117, s61, 1
    v_writelane_b32 v116, s69, 1
    v_writelane_b32 v117, s62, 2
    v_writelane_b32 v116, s70, 2
    v_writelane_b32 v117, s63, 3
    v_writelane_b32 v116, s71, 3
    v_writelane_b32 v117, s64, 4
    v_writelane_b32 v116, s72, 4
    v_writelane_b32 v117, s65, 5
    v_writelane_b32 v116, s73, 5
    v_writelane_b32 v117, s66, 6
    v_writelane_b32 v116, s74, 6
    v_writelane_b32 v117, s67, 7
    v_writelane_b32 v116, s75, 7
    s_nop 1
    v_mul_f32 v117, 0x3b124925, v117
    v_mul_f32 v116, 0x3b124925, v116
    v_fma_f32 v116, -v117, v117, v116
    v_max_f32 v116, 0, v116
    v_cvt_pk_bf16_f32 v118, v116, v117
    v_lshlrev_b32 v116, 16, v118
    v_and_b32 v117, 0xffff0000, v118
    v_add_f32 v116, 0x3727c5ac, v116
    v_cvt_pk_bf16_f32 v116, v116, v116
    v_lshlrev_b32 v116, 16, v116
    v_sqrt_f32 v116, v116
    s_nop 0
    v_cvt_pk_bf16_f32 v116, v116, v116
    v_lshlrev_b32 v116, 16, v116
    v_rcp_f32 v116, v116
    s_nop 1
    v_readlane_b32 s20, v117, 0
    v_readlane_b32 s60, v116, 0
    v_readlane_b32 s22, v117, 1
    v_readlane_b32 s62, v116, 1
    v_readlane_b32 s24, v117, 2
    v_readlane_b32 s64, v116, 2
    v_readlane_b32 s26, v117, 3
    v_readlane_b32 s66, v116, 3
    v_readlane_b32 s28, v117, 4
    v_readlane_b32 s68, v116, 4
    v_readlane_b32 s30, v117, 5
    v_readlane_b32 s70, v116, 5
    v_readlane_b32 s32, v117, 6
    v_readlane_b32 s72, v116, 6
    v_readlane_b32 s34, v117, 7
    v_readlane_b32 s74, v116, 7
    s_nop 2
    v_pk_add_f32 v[40:41], v[40:41], s[20:21] op_sel_hi:[1,0] neg_lo:[0,1] neg_hi:[0,1]
    v_pk_add_f32 v[48:49], v[48:49], s[22:23] op_sel_hi:[1,0] neg_lo:[0,1] neg_hi:[0,1]
    v_pk_add_f32 v[56:57], v[56:57], s[24:25] op_sel_hi:[1,0] neg_lo:[0,1] neg_hi:[0,1]
    v_pk_add_f32 v[64:65], v[64:65], s[26:27] op_sel_hi:[1,0] neg_lo:[0,1] neg_hi:[0,1]
    v_pk_add_f32 v[42:43], v[42:43], s[20:21] op_sel_hi:[1,0] neg_lo:[0,1] neg_hi:[0,1]
    v_pk_add_f32 v[50:51], v[50:51], s[22:23] op_sel_hi:[1,0] neg_lo:[0,1] neg_hi:[0,1]
    v_pk_add_f32 v[58:59], v[58:59], s[24:25] op_sel_hi:[1,0] neg_lo:[0,1] neg_hi:[0,1]
    v_pk_add_f32 v[66:67], v[66:67], s[26:27] op_sel_hi:[1,0] neg_lo:[0,1] neg_hi:[0,1]
    v_pk_add_f32 v[44:45], v[44:45], s[20:21] op_sel_hi:[1,0] neg_lo:[0,1] neg_hi:[0,1]
    v_pk_add_f32 v[52:53], v[52:53], s[22:23] op_sel_hi:[1,0] neg_lo:[0,1] neg_hi:[0,1]
    v_pk_add_f32 v[60:61], v[60:61], s[24:25] op_sel_hi:[1,0] neg_lo:[0,1] neg_hi:[0,1]
    v_pk_add_f32 v[68:69], v[68:69], s[26:27] op_sel_hi:[1,0] neg_lo:[0,1] neg_hi:[0,1]
    v_pk_add_f32 v[46:47], v[46:47], s[20:21] op_sel_hi:[1,0] neg_lo:[0,1] neg_hi:[0,1]
    v_pk_add_f32 v[54:55], v[54:55], s[22:23] op_sel_hi:[1,0] neg_lo:[0,1] neg_hi:[0,1]
    v_pk_add_f32 v[62:63], v[62:63], s[24:25] op_sel_hi:[1,0] neg_lo:[0,1] neg_hi:[0,1]
    v_pk_add_f32 v[70:71], v[70:71], s[26:27] op_sel_hi:[1,0] neg_lo:[0,1] neg_hi:[0,1]
    v_cvt_pk_bf16_f32 v104, v40, v41
    v_cvt_pk_bf16_f32 v105, v42, v43
    v_cvt_pk_bf16_f32 v106, v44, v45
    v_cvt_pk_bf16_f32 v107, v46, v47
    v_cvt_pk_bf16_f32 v108, v48, v49
    v_cvt_pk_bf16_f32 v109, v50, v51
    v_cvt_pk_bf16_f32 v110, v52, v53
    v_cvt_pk_bf16_f32 v111, v54, v55
    v_cvt_pk_bf16_f32 v112, v56, v57
    v_cvt_pk_bf16_f32 v113, v58, v59
    v_cvt_pk_bf16_f32 v114, v60, v61
    v_cvt_pk_bf16_f32 v115, v62, v63
    v_cvt_pk_bf16_f32 v116, v64, v65
    v_cvt_pk_bf16_f32 v117, v66, v67
    v_cvt_pk_bf16_f32 v118, v68, v69
    v_cvt_pk_bf16_f32 v119, v70, v71
    v_lshlrev_b32 v40, 16, v104
    v_and_b32 v41, 0xffff0000, v104
    v_lshlrev_b32 v42, 16, v105
    v_and_b32 v43, 0xffff0000, v105
    v_lshlrev_b32 v44, 16, v106
    v_and_b32 v45, 0xffff0000, v106
    v_lshlrev_b32 v46, 16, v107
    v_and_b32 v47, 0xffff0000, v107
    v_lshlrev_b32 v48, 16, v108
    v_and_b32 v49, 0xffff0000, v108
    v_lshlrev_b32 v50, 16, v109
    v_and_b32 v51, 0xffff0000, v109
    v_lshlrev_b32 v52, 16, v110
    v_and_b32 v53, 0xffff0000, v110
    v_lshlrev_b32 v54, 16, v111
    v_and_b32 v55, 0xffff0000, v111
    v_lshlrev_b32 v56, 16, v112
    v_and_b32 v57, 0xffff0000, v112
    v_lshlrev_b32 v58, 16, v113
    v_and_b32 v59, 0xffff0000, v113
    v_lshlrev_b32 v60, 16, v114
    v_and_b32 v61, 0xffff0000, v114
    v_lshlrev_b32 v62, 16, v115
    v_and_b32 v63, 0xffff0000, v115
    v_lshlrev_b32 v64, 16, v116
    v_and_b32 v65, 0xffff0000, v116
    v_lshlrev_b32 v66, 16, v117
    v_and_b32 v67, 0xffff0000, v117
    v_lshlrev_b32 v68, 16, v118
    v_and_b32 v69, 0xffff0000, v118
    v_lshlrev_b32 v70, 16, v119
    v_and_b32 v71, 0xffff0000, v119
    v_pk_mul_f32 v[40:41], v[40:41], s[60:61] op_sel_hi:[1,0]
    v_pk_mul_f32 v[48:49], v[48:49], s[62:63] op_sel_hi:[1,0]
    v_pk_mul_f32 v[56:57], v[56:57], s[64:65] op_sel_hi:[1,0]
    v_pk_mul_f32 v[64:65], v[64:65], s[66:67] op_sel_hi:[1,0]
    v_pk_mul_f32 v[42:43], v[42:43], s[60:61] op_sel_hi:[1,0]
    v_pk_mul_f32 v[50:51], v[50:51], s[62:63] op_sel_hi:[1,0]
    v_pk_mul_f32 v[58:59], v[58:59], s[64:65] op_sel_hi:[1,0]
    v_pk_mul_f32 v[66:67], v[66:67], s[66:67] op_sel_hi:[1,0]
    v_pk_mul_f32 v[44:45], v[44:45], s[60:61] op_sel_hi:[1,0]
    v_pk_mul_f32 v[52:53], v[52:53], s[62:63] op_sel_hi:[1,0]
    v_pk_mul_f32 v[60:61], v[60:61], s[64:65] op_sel_hi:[1,0]
    v_pk_mul_f32 v[68:69], v[68:69], s[66:67] op_sel_hi:[1,0]
    v_pk_mul_f32 v[46:47], v[46:47], s[60:61] op_sel_hi:[1,0]
    v_pk_mul_f32 v[54:55], v[54:55], s[62:63] op_sel_hi:[1,0]
    v_pk_mul_f32 v[62:63], v[62:63], s[64:65] op_sel_hi:[1,0]
    v_pk_mul_f32 v[70:71], v[70:71], s[66:67] op_sel_hi:[1,0]
    v_pk_add_f32 v[72:73], v[72:73], s[28:29] op_sel_hi:[1,0] neg_lo:[0,1] neg_hi:[0,1]
    v_pk_add_f32 v[80:81], v[80:81], s[30:31] op_sel_hi:[1,0] neg_lo:[0,1] neg_hi:[0,1]
    v_pk_add_f32 v[88:89], v[88:89], s[32:33] op_sel_hi:[1,0] neg_lo:[0,1] neg_hi:[0,1]
    v_pk_add_f32 v[96:97], v[96:97], s[34:35] op_sel_hi:[1,0] neg_lo:[0,1] neg_hi:[0,1]
    v_pk_add_f32 v[74:75], v[74:75], s[28:29] op_sel_hi:[1,0] neg_lo:[0,1] neg_hi:[0,1]
    v_pk_add_f32 v[82:83], v[82:83], s[30:31] op_sel_hi:[1,0] neg_lo:[0,1] neg_hi:[0,1]
    v_pk_add_f32 v[90:91], v[90:91], s[32:33] op_sel_hi:[1,0] neg_lo:[0,1] neg_hi:[0,1]
    v_pk_add_f32 v[98:99], v[98:99], s[34:35] op_sel_hi:[1,0] neg_lo:[0,1] neg_hi:[0,1]
    v_pk_add_f32 v[76:77], v[76:77], s[28:29] op_sel_hi:[1,0] neg_lo:[0,1] neg_hi:[0,1]
    v_pk_add_f32 v[84:85], v[84:85], s[30:31] op_sel_hi:[1,0] neg_lo:[0,1] neg_hi:[0,1]
    v_pk_add_f32 v[92:93], v[92:93], s[32:33] op_sel_hi:[1,0] neg_lo:[0,1] neg_hi:[0,1]
    v_pk_add_f32 v[100:101], v[100:101], s[34:35] op_sel_hi:[1,0] neg_lo:[0,1] neg_hi:[0,1]
    v_pk_add_f32 v[78:79], v[78:79], s[28:29] op_sel_hi:[1,0] neg_lo:[0,1] neg_hi:[0,1]
    v_pk_add_f32 v[86:87], v[86:87], s[30:31] op_sel_hi:[1,0] neg_lo:[0,1] neg_hi:[0,1]
    v_pk_add_f32 v[94:95], v[94:95], s[32:33] op_sel_hi:[1,0] neg_lo:[0,1] neg_hi:[0,1]
    v_pk_add_f32 v[102:103], v[102:103], s[34:35] op_sel_hi:[1,0] neg_lo:[0,1] neg_hi:[0,1]
    v_cvt_pk_bf16_f32 v104, v72, v73
    v_cvt_pk_bf16_f32 v105, v74, v75
    v_cvt_pk_bf16_f32 v106, v76, v77
    v_cvt_pk_bf16_f32 v107, v78, v79
    v_cvt_pk_bf16_f32 v108, v80, v81
    v_cvt_pk_bf16_f32 v109, v82, v83
    v_cvt_pk_bf16_f32 v110, v84, v85
    v_cvt_pk_bf16_f32 v111, v86, v87
    v_cvt_pk_bf16_f32 v112, v88, v89
    v_cvt_pk_bf16_f32 v113, v90, v91
    v_cvt_pk_bf16_f32 v114, v92, v93
    v_cvt_pk_bf16_f32 v115, v94, v95
    v_cvt_pk_bf16_f32 v116, v96, v97
    v_cvt_pk_bf16_f32 v117, v98, v99
    v_cvt_pk_bf16_f32 v118, v100, v101
    v_cvt_pk_bf16_f32 v119, v102, v103
    v_lshlrev_b32 v72, 16, v104
    v_and_b32 v73, 0xffff0000, v104
    v_lshlrev_b32 v74, 16, v105
    v_and_b32 v75, 0xffff0000, v105
    v_lshlrev_b32 v76, 16, v106
    v_and_b32 v77, 0xffff0000, v106
    v_lshlrev_b32 v78, 16, v107
    v_and_b32 v79, 0xffff0000, v107
    v_lshlrev_b32 v80, 16, v108
    v_and_b32 v81, 0xffff0000, v108
    v_lshlrev_b32 v82, 16, v109
    v_and_b32 v83, 0xffff0000, v109
    v_lshlrev_b32 v84, 16, v110
    v_and_b32 v85, 0xffff0000, v110
    v_lshlrev_b32 v86, 16, v111
    v_and_b32 v87, 0xffff0000, v111
    v_lshlrev_b32 v88, 16, v112
    v_and_b32 v89, 0xffff0000, v112
    v_lshlrev_b32 v90, 16, v113
    v_and_b32 v91, 0xffff0000, v113
    v_lshlrev_b32 v92, 16, v114
    v_and_b32 v93, 0xffff0000, v114
    v_lshlrev_b32 v94, 16, v115
    v_and_b32 v95, 0xffff0000, v115
    v_lshlrev_b32 v96, 16, v116
    v_and_b32 v97, 0xffff0000, v116
    v_lshlrev_b32 v98, 16, v117
    v_and_b32 v99, 0xffff0000, v117
    v_lshlrev_b32 v100, 16, v118
    v_and_b32 v101, 0xffff0000, v118
    v_lshlrev_b32 v102, 16, v119
    v_and_b32 v103, 0xffff0000, v119
    v_pk_mul_f32 v[72:73], v[72:73], s[68:69] op_sel_hi:[1,0]
    v_pk_mul_f32 v[80:81], v[80:81], s[70:71] op_sel_hi:[1,0]
    v_pk_mul_f32 v[88:89], v[88:89], s[72:73] op_sel_hi:[1,0]
    v_pk_mul_f32 v[96:97], v[96:97], s[74:75] op_sel_hi:[1,0]
    v_pk_mul_f32 v[74:75], v[74:75], s[68:69] op_sel_hi:[1,0]
    v_pk_mul_f32 v[82:83], v[82:83], s[70:71] op_sel_hi:[1,0]
    v_pk_mul_f32 v[90:91], v[90:91], s[72:73] op_sel_hi:[1,0]
    v_pk_mul_f32 v[98:99], v[98:99], s[74:75] op_sel_hi:[1,0]
    v_pk_mul_f32 v[76:77], v[76:77], s[68:69] op_sel_hi:[1,0]
    v_pk_mul_f32 v[84:85], v[84:85], s[70:71] op_sel_hi:[1,0]
    v_pk_mul_f32 v[92:93], v[92:93], s[72:73] op_sel_hi:[1,0]
    v_pk_mul_f32 v[100:101], v[100:101], s[74:75] op_sel_hi:[1,0]
    v_pk_mul_f32 v[78:79], v[78:79], s[68:69] op_sel_hi:[1,0]
    v_pk_mul_f32 v[86:87], v[86:87], s[70:71] op_sel_hi:[1,0]
    v_pk_mul_f32 v[94:95], v[94:95], s[72:73] op_sel_hi:[1,0]
    v_pk_mul_f32 v[102:103], v[102:103], s[74:75] op_sel_hi:[1,0]
    v_cvt_pk_bf16_f32 v136, v96, v88
    v_cvt_pk_bf16_f32 v137, v80, v72
    v_cvt_pk_bf16_f32 v138, v64, v56
    v_cvt_pk_bf16_f32 v139, v48, v40
    ds_write_b128 v5, v[136:139] offset:0
    v_cvt_pk_bf16_f32 v140, v97, v89
    v_cvt_pk_bf16_f32 v141, v81, v73
    v_cvt_pk_bf16_f32 v142, v65, v57
    v_cvt_pk_bf16_f32 v143, v49, v41
    ds_write_b128 v5, v[140:143] offset:80
    v_cvt_pk_bf16_f32 v144, v98, v90
    v_cvt_pk_bf16_f32 v145, v82, v74
    v_cvt_pk_bf16_f32 v146, v66, v58
    v_cvt_pk_bf16_f32 v147, v50, v42
    ds_write_b128 v5, v[144:147] offset:160
    v_cvt_pk_bf16_f32 v148, v99, v91
    v_cvt_pk_bf16_f32 v149, v83, v75
    v_cvt_pk_bf16_f32 v150, v67, v59
    v_cvt_pk_bf16_f32 v151, v51, v43
    ds_write_b128 v5, v[148:151] offset:240
    v_cvt_pk_bf16_f32 v152, v100, v92
    v_cvt_pk_bf16_f32 v153, v84, v76
    v_cvt_pk_bf16_f32 v154, v68, v60
    v_cvt_pk_bf16_f32 v155, v52, v44
    ds_write_b128 v5, v[152:155] offset:320
    v_cvt_pk_bf16_f32 v156, v101, v93
    v_cvt_pk_bf16_f32 v157, v85, v77
    v_cvt_pk_bf16_f32 v158, v69, v61
    v_cvt_pk_bf16_f32 v159, v53, v45
    ds_write_b128 v5, v[156:159] offset:400
    v_cvt_pk_bf16_f32 v160, v102, v94
    v_cvt_pk_bf16_f32 v161, v86, v78
    v_cvt_pk_bf16_f32 v162, v70, v62
    v_cvt_pk_bf16_f32 v163, v54, v46
    ds_write_b128 v5, v[160:163] offset:480
    v_cvt_pk_bf16_f32 v164, v103, v95
    v_cvt_pk_bf16_f32 v165, v87, v79
    v_cvt_pk_bf16_f32 v166, v71, v63
    v_cvt_pk_bf16_f32 v167, v55, v47
    ds_write_b128 v5, v[164:167] offset:560
    v_lshrrev_b32 v5, 2, v0
    v_and_b32 v6, 3, v0
    v_mul_u32_u24 v7, 80, v5
    v_lshl_add_u32 v7, v6, 4, v7
    v_add_u32 v4, 35840, v7
    v_mul_u32_u24 v5, 4352, v5
    v_lshl_add_u32 v5, v6, 4, v5
    s_lshl_b32 s46, s2, 6
    s_sub_u32 s47, 4032, s46
    s_waitcnt lgkmcnt(0)
    s_barrier
    ds_read_b128 v[8:11], v7 offset:0
    ds_read_b128 v[12:15], v7 offset:5120
    ds_read_b128 v[16:19], v7 offset:10240
    ds_read_b128 v[20:23], v7 offset:15360
    ds_read_b128 v[24:27], v7 offset:20480
    ds_read_b128 v[28:31], v7 offset:25600
    ds_read_b128 v[32:35], v7 offset:30720
    s_waitcnt lgkmcnt(6)
    buffer_store_dwordx4 v[8:11], v5, s[12:15], s47 offen sc1
    s_add_u32 s47, s47, 278528
    s_waitcnt lgkmcnt(5)
    buffer_store_dwordx4 v[12:15], v5, s[12:15], s47 offen sc1
    s_add_u32 s47, s47, 278528
    s_waitcnt lgkmcnt(4)
    buffer_store_dwordx4 v[16:19], v5, s[12:15], s47 offen sc1
    s_add_u32 s47, s47, 278528
    s_waitcnt lgkmcnt(3)
    buffer_store_dwordx4 v[20:23], v5, s[12:15], s47 offen sc1
    s_add_u32 s47, s47, 278528
    s_waitcnt lgkmcnt(2)
    buffer_store_dwordx4 v[24:27], v5, s[12:15], s47 offen sc1
    s_add_u32 s47, s47, 278528
    s_waitcnt lgkmcnt(1)
    buffer_store_dwordx4 v[28:31], v5, s[12:15], s47 offen sc1
    s_add_u32 s47, s47, 278528
    s_waitcnt lgkmcnt(0)
    buffer_store_dwordx4 v[32:35], v5, s[12:15], s47 offen sc1
    s_endpgm
K1_KGEN:
    s_load_dwordx4 s[4:7], s[0:1], 8
    s_load_dwordx4 s[8:11], s[0:1], 24
    s_load_dwordx4 s[12:15], s[0:1], 40
    s_load_dwordx2 s[16:17], s[0:1], 56
    s_load_dwordx2 s[18:19], s[0:1], 120
    s_load_dwordx2 s[56:57], s[0:1], 0
    s_sub_u32 s3, s2, 64
    v_lshlrev_b32 v1, 1, v0
    s_lshl_b32 s20, s3, 9
    s_lshl_b32 s21, s3, 1
    v_mov_b32 v9, 0
    s_waitcnt lgkmcnt(0)
    s_mov_b32 s24, s4
    s_mov_b32 s25, s5
    s_mov_b32 s26, 229376
    s_mov_b32 s27, 0x00020000
    s_mov_b32 s28, s6
    s_mov_b32 s29, s7
    s_mov_b32 s30, 229376
    s_mov_b32 s31, 0x00020000
    s_mov_b32 s32, s8
    s_mov_b32 s33, s9
    s_mov_b32 s34, 229376
    s_mov_b32 s35, 0x00020000
    s_mov_b32 s36, s10
    s_mov_b32 s37, s11
    s_mov_b32 s38, 229376
    s_mov_b32 s39, 0x00020000
    s_mov_b32 s40, s12
    s_mov_b32 s41, s13
    s_mov_b32 s42, 229376
    s_mov_b32 s43, 0x00020000
    s_mov_b32 s44, s14
    s_mov_b32 s45, s15
    s_mov_b32 s46, 229376
    s_mov_b32 s47, 0x00020000
    s_mov_b32 s48, s16
    s_mov_b32 s49, s17
    s_mov_b32 s50, 896
    s_mov_b32 s51, 0x00020000
    s_add_u32 s52, s18, 3899392
    s_addc_u32 s53, s19, 0
    s_mov_b32 s54, 2064384
    s_mov_b32 s55, 0x00020000
    buffer_load_ushort v2, v1, s[24:27], s20 offen
    buffer_load_ushort v3, v1, s[28:31], s20 offen
    buffer_load_ushort v4, v1, s[32:35], s20 offen
    buffer_load_ushort v5, v1, s[36:39], s20 offen
    buffer_load_ushort v6, v1, s[40:43], s20 offen
    buffer_load_ushort v7, v1, s[44:47], s20 offen
    buffer_load_ushort v8, v9, s[48:51], s21 offen
    s_mul_i32 s58, s3, 9363
    s_lshr_b32 s58, s58, 16
    s_mul_i32 s59, s58, 7
    s_sub_u32 s59, s3, s59
    s_mov_b32 s60, s56
    s_mov_b32 s61, s57
    s_mov_b32 s62, 1835008
    s_mov_b32 s63, 0x00020000
    s_add_u32 s64, s18, 1949696
    s_addc_u32 s65, s19, 0
    s_mov_b32 s66, 1949696
    s_mov_b32 s67, 0x00020000
    v_lshrrev_b32 v116, 3, v0
    v_and_b32 v117, 7, v0
    v_mul_u32_u24 v118, 896, v116
    v_lshl_add_u32 v118, v117, 4, v118
    s_mul_i32 s68, s58, 28672
    s_lshl_b32 s69, s59, 7
    s_add_u32 s68, s68, s69
    buffer_load_dwordx4 v[120:123], v118, s[60:63], s68 offen
    v_mul_u32_u24 v118, 640, v117
    v_lshl_add_u32 v118, v116, 1, v118
    v_lshrrev_b32 v116, 2, v0
    v_and_b32 v117, 3, v0
    v_mul_u32_u24 v119, 80, v116
    v_lshl_add_u32 v119, v117, 4, v119
    v_mul_u32_u24 v116, 4352, v116
    v_lshl_add_u32 v116, v117, 4, v116
    s_mul_i32 s68, s59, 278528
    s_lshl_b32 s69, s58, 6
    s_add_u32 s68, s68, s69
    v_lshlrev_b32 v1, 2, v0
    v_lshlrev_b32 v50, 3, v0
    v_subrev_u32 v50, 63, v50
    v_and_b32 v51, 31, v0
    v_lshlrev_b32 v51, 3, v51
    v_add_u32 v51, 1985, v51
    v_mov_b32 v52, 75320
    v_lshrrev_b32 v53, 6, v0
    s_nop 0
    v_readfirstlane_b32 s22, v53
    v_add_u32 v53, 0, v50
    v_add_u32 v54, 1, v50
    v_cvt_f32_u32 v55, v53
    v_cvt_f32_u32 v56, v54
    v_cvt_pk_bf16_f32 v57, v55, v56
    v_lshlrev_b32 v55, 16, v57
    v_and_b32 v56, 0xffff0000, v57
    v_cvt_u32_f32 v55, v55
    v_cvt_u32_f32 v56, v56
    v_lshlrev_b32 v55, 2, v55
    v_lshlrev_b32 v56, 2, v56
    v_add_u32 v55, 66560, v55
    v_add_u32 v56, 66560, v56
    v_cmp_lt_u32 vcc, 2047, v53
    s_nop 1
    v_cndmask_b32 v64, v55, v52, vcc
    v_cmp_lt_u32 vcc, 2047, v54
    s_nop 1
    v_cndmask_b32 v65, v56, v52, vcc
    v_add_u32 v53, 2, v50
    v_add_u32 v54, 3, v50
    v_cvt_f32_u32 v55, v53
    v_cvt_f32_u32 v56, v54
    v_cvt_pk_bf16_f32 v57, v55, v56
    v_lshlrev_b32 v55, 16, v57
    v_and_b32 v56, 0xffff0000, v57
    v_cvt_u32_f32 v55, v55
    v_cvt_u32_f32 v56, v56
    v_lshlrev_b32 v55, 2, v55
    v_lshlrev_b32 v56, 2, v56
    v_add_u32 v55, 66560, v55
    v_add_u32 v56, 66560, v56
    v_cmp_lt_u32 vcc, 2047, v53
    s_nop 1
    v_cndmask_b32 v66, v55, v52, vcc
    v_cmp_lt_u32 vcc, 2047, v54
    s_nop 1
    v_cndmask_b32 v67, v56, v52, vcc
    v_add_u32 v53, 4, v50
    v_add_u32 v54, 5, v50
    v_cvt_f32_u32 v55, v53
    v_cvt_f32_u32 v56, v54
    v_cvt_pk_bf16_f32 v57, v55, v56
    v_lshlrev_b32 v55, 16, v57
    v_and_b32 v56, 0xffff0000, v57
    v_cvt_u32_f32 v55, v55
    v_cvt_u32_f32 v56, v56
    v_lshlrev_b32 v55, 2, v55
    v_lshlrev_b32 v56, 2, v56
    v_add_u32 v55, 66560, v55
    v_add_u32 v56, 66560, v56
    v_cmp_lt_u32 vcc, 2047, v53
    s_nop 1
    v_cndmask_b32 v68, v55, v52, vcc
    v_cmp_lt_u32 vcc, 2047, v54
    s_nop 1
    v_cndmask_b32 v69, v56, v52, vcc
    v_add_u32 v53, 6, v50
    v_add_u32 v54, 7, v50
    v_cvt_f32_u32 v55, v53
    v_cvt_f32_u32 v56, v54
    v_cvt_pk_bf16_f32 v57, v55, v56
    v_lshlrev_b32 v55, 16, v57
    v_and_b32 v56, 0xffff0000, v57
    v_cvt_u32_f32 v55, v55
    v_cvt_u32_f32 v56, v56
    v_lshlrev_b32 v55, 2, v55
    v_lshlrev_b32 v56, 2, v56
    v_add_u32 v55, 66560, v55
    v_add_u32 v56, 66560, v56
    v_cmp_lt_u32 vcc, 2047, v53
    s_nop 1
    v_cndmask_b32 v70, v55, v52, vcc
    v_cmp_lt_u32 vcc, 2047, v54
    s_nop 1
    v_cndmask_b32 v71, v56, v52, vcc
    s_cmp_eq_u32 s22, 0
    s_cbranch_scc0 K1_NOP2
    v_add_u32 v53, 0, v51
    v_add_u32 v54, 1, v51
    v_cvt_f32_u32 v55, v53
    v_cvt_f32_u32 v56, v54
    v_cvt_pk_bf16_f32 v57, v55, v56
    v_lshlrev_b32 v55, 16, v57
    v_and_b32 v56, 0xffff0000, v57
    v_cvt_u32_f32 v55, v55
    v_cvt_u32_f32 v56, v56
    v_lshlrev_b32 v55, 2, v55
    v_lshlrev_b32 v56, 2, v56
    v_add_u32 v55, 66560, v55
    v_add_u32 v56, 66560, v56
    v_cmp_lt_u32 vcc, 2047, v53
    s_nop 1
    v_cndmask_b32 v74, v55, v52, vcc
    v_cmp_lt_u32 vcc, 2047, v54
    s_nop 1
    v_cndmask_b32 v75, v56, v52, vcc
    v_add_u32 v53, 2, v51
    v_add_u32 v54, 3, v51
    v_cvt_f32_u32 v55, v53
    v_cvt_f32_u32 v56, v54
    v_cvt_pk_bf16_f32 v57, v55, v56
    v_lshlrev_b32 v55, 16, v57
    v_and_b32 v56, 0xffff0000, v57
    v_cvt_u32_f32 v55, v55
    v_cvt_u32_f32 v56, v56
    v_lshlrev_b32 v55, 2, v55
    v_lshlrev_b32 v56, 2, v56
    v_add_u32 v55, 66560, v55
    v_add_u32 v56, 66560, v56
    v_cmp_lt_u32 vcc, 2047, v53
    s_nop 1
    v_cndmask_b32 v76, v55, v52, vcc
    v_cmp_lt_u32 vcc, 2047, v54
    s_nop 1
    v_cndmask_b32 v77, v56, v52, vcc
    v_add_u32 v53, 4, v51
    v_add_u32 v54, 5, v51
    v_cvt_f32_u32 v55, v53
    v_cvt_f32_u32 v56, v54
    v_cvt_pk_bf16_f32 v57, v55, v56
    v_lshlrev_b32 v55, 16, v57
    v_and_b32 v56, 0xffff0000, v57
    v_cvt_u32_f32 v55, v55
    v_cvt_u32_f32 v56, v56
    v_lshlrev_b32 v55, 2, v55
    v_lshlrev_b32 v56, 2, v56
    v_add_u32 v55, 66560, v55
    v_add_u32 v56, 66560, v56
    v_cmp_lt_u32 vcc, 2047, v53
    s_nop 1
    v_cndmask_b32 v78, v55, v52, vcc
    v_cmp_lt_u32 vcc, 2047, v54
    s_nop 1
    v_cndmask_b32 v79, v56, v52, vcc
    v_add_u32 v53, 6, v51
    v_add_u32 v54, 7, v51
    v_cvt_f32_u32 v55, v53
    v_cvt_f32_u32 v56, v54
    v_cvt_pk_bf16_f32 v57, v55, v56
    v_lshlrev_b32 v55, 16, v57
    v_and_b32 v56, 0xffff0000, v57
    v_cvt_u32_f32 v55, v55
    v_cvt_u32_f32 v56, v56
    v_lshlrev_b32 v55, 2, v55
    v_lshlrev_b32 v56, 2, v56
    v_add_u32 v55, 66560, v55
    v_add_u32 v56, 66560, v56
    v_cmp_lt_u32 vcc, 2047, v53
    s_nop 1
    v_cndmask_b32 v80, v55, v52, vcc
    v_cmp_lt_u32 vcc, 2047, v54
    s_nop 1
    v_cndmask_b32 v81, v56, v52, vcc
K1_NOP2:
    v_mov_b32 v53, 0
    ds_write_b32 v52, v53
    s_waitcnt vmcnt(0)
    v_lshlrev_b32 v2, 16, v2
    v_lshlrev_b32 v3, 16, v3
    v_lshlrev_b32 v4, 16, v4
    v_lshlrev_b32 v5, 16, v5
    v_lshlrev_b32 v6, 16, v6
    v_lshlrev_b32 v7, 16, v7
    v_lshlrev_b32 v8, 16, v8
    v_mul_f32 v8, 0x3fb8aa3b, v8
    v_exp_f32 v8, v8
    s_nop 0
    v_cvt_pk_bf16_f32 v8, v8, v8
    v_lshlrev_b32 v8, 16, v8
    v_mul_f32 v10, v8, v2
    v_mul_f32 v11, v8, v3
    v_mul_f32 v4, v8, v4
    v_mul_f32 v5, v8, v5
    v_pk_mul_f32 v[30:31], v[6:7], v[4:5] op_sel:[0,0] op_sel_hi:[1,0]
    v_pk_fma_f32 v[30:31], v[6:7], v[4:5], v[30:31] op_sel:[1,1,0] op_sel_hi:[0,1,1] neg_lo:[1,0,0]
    v_mul_f32 v46, 0x3fb8aa3b, v10
    v_mul_f32 v47, 0x3e22f983, v11
    v_exp_f32 v46, v46
    v_fract_f32 v47, v47
    v_cos_f32 v48, v47
    v_sin_f32 v49, v47
    s_nop 0
    v_mul_f32 v12, v46, v48
    v_mul_f32 v13, v46, v49
    v_mul_f32 v46, 0x4138aa3b, v10
    v_mul_f32 v47, 0x3fa2f983, v11
    v_exp_f32 v46, v46
    v_fract_f32 v47, v47
    v_cos_f32 v48, v47
    v_sin_f32 v49, v47
    s_nop 0
    v_mul_f32 v26, v46, v48
    v_mul_f32_e64 v27, -v46, v49
    v_mul_f32 v46, 0x4338aa3b, v10
    v_mul_f32 v47, 0x41a2f983, v11
    v_exp_f32 v46, v46
    v_fract_f32 v47, v47
    v_cos_f32 v48, v47
    v_sin_f32 v49, v47
    s_nop 0
    v_mul_f32 v28, v46, v48
    v_mul_f32 v29, v46, v49
    v_pk_mul_f32 v[14:15], v[12:13], v[12:13] op_sel:[0,0] op_sel_hi:[1,0]
    v_pk_fma_f32 v[14:15], v[12:13], v[12:13], v[14:15] op_sel:[1,1,0] op_sel_hi:[0,1,1] neg_lo:[1,0,0]
    v_pk_mul_f32 v[16:17], v[14:15], v[12:13] op_sel:[0,0] op_sel_hi:[1,0]
    v_pk_fma_f32 v[16:17], v[14:15], v[12:13], v[16:17] op_sel:[1,1,0] op_sel_hi:[0,1,1] neg_lo:[1,0,0]
    v_pk_mul_f32 v[18:19], v[14:15], v[14:15] op_sel:[0,0] op_sel_hi:[1,0]
    v_pk_fma_f32 v[18:19], v[14:15], v[14:15], v[18:19] op_sel:[1,1,0] op_sel_hi:[0,1,1] neg_lo:[1,0,0]
    v_pk_mul_f32 v[20:21], v[18:19], v[12:13] op_sel:[0,0] op_sel_hi:[1,0]
    v_pk_fma_f32 v[20:21], v[18:19], v[12:13], v[20:21] op_sel:[1,1,0] op_sel_hi:[0,1,1] neg_lo:[1,0,0]
    v_pk_mul_f32 v[22:23], v[18:19], v[14:15] op_sel:[0,0] op_sel_hi:[1,0]
    v_pk_fma_f32 v[22:23], v[18:19], v[14:15], v[22:23] op_sel:[1,1,0] op_sel_hi:[0,1,1] neg_lo:[1,0,0]
    v_pk_mul_f32 v[24:25], v[18:19], v[16:17] op_sel:[0,0] op_sel_hi:[1,0]
    v_pk_fma_f32 v[24:25], v[18:19], v[16:17], v[24:25] op_sel:[1,1,0] op_sel_hi:[0,1,1] neg_lo:[1,0,0]
    v_mov_b32 v34, 1.0
    v_mov_b32 v35, 0
    v_cvt_pk_bf16_f32 v42, v34, v35
    ds_write_b32 v1, v42 offset:49920
    v_cvt_pk_bf16_f32 v43, v26, v27
    ds_write_b32 v1, v43 offset:50960
    v_pk_mul_f32 v[34:35], v[26:27], v[26:27] op_sel:[0,0] op_sel_hi:[1,0]
    v_pk_fma_f32 v[34:35], v[26:27], v[26:27], v[34:35] op_sel:[1,1,0] op_sel_hi:[0,1,1] neg_lo:[1,0,0]
    v_cvt_pk_bf16_f32 v44, v34, v35
    ds_write_b32 v1, v44 offset:52000
    v_pk_mul_f32 v[36:37], v[34:35], v[26:27] op_sel:[0,0] op_sel_hi:[1,0]
    v_pk_fma_f32 v[36:37], v[34:35], v[26:27], v[36:37] op_sel:[1,1,0] op_sel_hi:[0,1,1] neg_lo:[1,0,0]
    v_cvt_pk_bf16_f32 v45, v36, v37
    ds_write_b32 v1, v45 offset:53040
    v_pk_mul_f32 v[34:35], v[36:37], v[26:27] op_sel:[0,0] op_sel_hi:[1,0]
    v_pk_fma_f32 v[34:35], v[36:37], v[26:27], v[34:35] op_sel:[1,1,0] op_sel_hi:[0,1,1] neg_lo:[1,0,0]
    v_cvt_pk_bf16_f32 v42, v34, v35
    ds_write_b32 v1, v42 offset:54080
    v_pk_mul_f32 v[36:37], v[34:35], v[26:27] op_sel:[0,0] op_sel_hi:[1,0]
    v_pk_fma_f32 v[36:37], v[34:35], v[26:27], v[36:37] op_sel:[1,1,0] op_sel_hi:[0,1,1] neg_lo:[1,0,0]
    v_cvt_pk_bf16_f32 v43, v36, v37
    ds_write_b32 v1, v43 offset:55120
    v_pk_mul_f32 v[34:35], v[36:37], v[26:27] op_sel:[0,0] op_sel_hi:[1,0]
    v_pk_fma_f32 v[34:35], v[36:37], v[26:27], v[34:35] op_sel:[1,1,0] op_sel_hi:[0,1,1] neg_lo:[1,0,0]
    v_cvt_pk_bf16_f32 v44, v34, v35
    ds_write_b32 v1, v44 offset:56160
    v_pk_mul_f32 v[36:37], v[34:35], v[26:27] op_sel:[0,0] op_sel_hi:[1,0]
    v_pk_fma_f32 v[36:37], v[34:35], v[26:27], v[36:37] op_sel:[1,1,0] op_sel_hi:[0,1,1] neg_lo:[1,0,0]
    v_cvt_pk_bf16_f32 v45, v36, v37
    ds_write_b32 v1, v45 offset:57200
    v_pk_mul_f32 v[34:35], v[36:37], v[26:27] op_sel:[0,0] op_sel_hi:[1,0]
    v_pk_fma_f32 v[34:35], v[36:37], v[26:27], v[34:35] op_sel:[1,1,0] op_sel_hi:[0,1,1] neg_lo:[1,0,0]
    v_cvt_pk_bf16_f32 v42, v34, v35
    ds_write_b32 v1, v42 offset:58240
    v_pk_mul_f32 v[36:37], v[34:35], v[26:27] op_sel:[0,0] op_sel_hi:[1,0]
    v_pk_fma_f32 v[36:37], v[34:35], v[26:27], v[36:37] op_sel:[1,1,0] op_sel_hi:[0,1,1] neg_lo:[1,0,0]
    v_cvt_pk_bf16_f32 v43, v36, v37
    ds_write_b32 v1, v43 offset:59280
    v_pk_mul_f32 v[34:35], v[36:37], v[26:27] op_sel:[0,0] op_sel_hi:[1,0]
    v_pk_fma_f32 v[34:35], v[36:37], v[26:27], v[34:35] op_sel:[1,1,0] op_sel_hi:[0,1,1] neg_lo:[1,0,0]
    v_cvt_pk_bf16_f32 v44, v34, v35
    ds_write_b32 v1, v44 offset:60320
    v_pk_mul_f32 v[36:37], v[34:35], v[26:27] op_sel:[0,0] op_sel_hi:[1,0]
    v_pk_fma_f32 v[36:37], v[34:35], v[26:27], v[36:37] op_sel:[1,1,0] op_sel_hi:[0,1,1] neg_lo:[1,0,0]
    v_cvt_pk_bf16_f32 v45, v36, v37
    ds_write_b32 v1, v45 offset:61360
    v_pk_mul_f32 v[34:35], v[36:37], v[26:27] op_sel:[0,0] op_sel_hi:[1,0]
    v_pk_fma_f32 v[34:35], v[36:37], v[26:27], v[34:35] op_sel:[1,1,0] op_sel_hi:[0,1,1] neg_lo:[1,0,0]
    v_cvt_pk_bf16_f32 v42, v34, v35
    ds_write_b32 v1, v42 offset:62400
    v_pk_mul_f32 v[36:37], v[34:35], v[26:27] op_sel:[0,0] op_sel_hi:[1,0]
    v_pk_fma_f32 v[36:37], v[34:35], v[26:27], v[36:37] op_sel:[1,1,0] op_sel_hi:[0,1,1] neg_lo:[1,0,0]
    v_cvt_pk_bf16_f32 v43, v36, v37
    ds_write_b32 v1, v43 offset:63440
    v_pk_mul_f32 v[34:35], v[36:37], v[26:27] op_sel:[0,0] op_sel_hi:[1,0]
    v_pk_fma_f32 v[34:35], v[36:37], v[26:27], v[34:35] op_sel:[1,1,0] op_sel_hi:[0,1,1] neg_lo:[1,0,0]
    v_cvt_pk_bf16_f32 v44, v34, v35
    ds_write_b32 v1, v44 offset:64480
    v_pk_mul_f32 v[36:37], v[34:35], v[26:27] op_sel:[0,0] op_sel_hi:[1,0]
    v_pk_fma_f32 v[36:37], v[34:35], v[26:27], v[36:37] op_sel:[1,1,0] op_sel_hi:[0,1,1] neg_lo:[1,0,0]
    v_cvt_pk_bf16_f32 v45, v36, v37
    ds_write_b32 v1, v45 offset:65520
    v_cvt_pk_bf16_f32 v42, v30, v31
    ds_write_b32 v1, v42 offset:0
    v_pk_mul_f32 v[38:39], v[30:31], v[12:13] op_sel:[0,0] op_sel_hi:[1,0]
    v_pk_fma_f32 v[38:39], v[30:31], v[12:13], v[38:39] op_sel:[1,1,0] op_sel_hi:[0,1,1] neg_lo:[1,0,0]
    v_cvt_pk_bf16_f32 v43, v38, v39
    ds_write_b32 v1, v43 offset:1040
    v_pk_mul_f32 v[40:41], v[30:31], v[14:15] op_sel:[0,0] op_sel_hi:[1,0]
    v_pk_fma_f32 v[40:41], v[30:31], v[14:15], v[40:41] op_sel:[1,1,0] op_sel_hi:[0,1,1] neg_lo:[1,0,0]
    v_cvt_pk_bf16_f32 v44, v40, v41
    ds_write_b32 v1, v44 offset:2080
    v_pk_mul_f32 v[38:39], v[30:31], v[16:17] op_sel:[0,0] op_sel_hi:[1,0]
    v_pk_fma_f32 v[38:39], v[30:31], v[16:17], v[38:39] op_sel:[1,1,0] op_sel_hi:[0,1,1] neg_lo:[1,0,0]
    v_cvt_pk_bf16_f32 v45, v38, v39
    ds_write_b32 v1, v45 offset:3120
    v_pk_mul_f32 v[40:41], v[30:31], v[18:19] op_sel:[0,0] op_sel_hi:[1,0]
    v_pk_fma_f32 v[40:41], v[30:31], v[18:19], v[40:41] op_sel:[1,1,0] op_sel_hi:[0,1,1] neg_lo:[1,0,0]
    v_cvt_pk_bf16_f32 v42, v40, v41
    ds_write_b32 v1, v42 offset:4160
    v_pk_mul_f32 v[38:39], v[30:31], v[20:21] op_sel:[0,0] op_sel_hi:[1,0]
    v_pk_fma_f32 v[38:39], v[30:31], v[20:21], v[38:39] op_sel:[1,1,0] op_sel_hi:[0,1,1] neg_lo:[1,0,0]
    v_cvt_pk_bf16_f32 v43, v38, v39
    ds_write_b32 v1, v43 offset:5200
    v_pk_mul_f32 v[40:41], v[30:31], v[22:23] op_sel:[0,0] op_sel_hi:[1,0]
    v_pk_fma_f32 v[40:41], v[30:31], v[22:23], v[40:41] op_sel:[1,1,0] op_sel_hi:[0,1,1] neg_lo:[1,0,0]
    v_cvt_pk_bf16_f32 v44, v40, v41
    ds_write_b32 v1, v44 offset:6240
    v_pk_mul_f32 v[38:39], v[30:31], v[24:25] op_sel:[0,0] op_sel_hi:[1,0]
    v_pk_fma_f32 v[38:39], v[30:31], v[24:25], v[38:39] op_sel:[1,1,0] op_sel_hi:[0,1,1] neg_lo:[1,0,0]
    v_cvt_pk_bf16_f32 v45, v38, v39
    ds_write_b32 v1, v45 offset:7280
    v_pk_mul_f32 v[32:33], v[30:31], v[28:29] op_sel:[0,0] op_sel_hi:[1,0]
    v_pk_fma_f32 v[32:33], v[30:31], v[28:29], v[32:33] op_sel:[1,1,0] op_sel_hi:[0,1,1] neg_lo:[1,0,0]
    v_cvt_pk_bf16_f32 v42, v32, v33
    ds_write_b32 v1, v42 offset:8320
    v_pk_mul_f32 v[40:41], v[32:33], v[12:13] op_sel:[0,0] op_sel_hi:[1,0]
    v_pk_fma_f32 v[40:41], v[32:33], v[12:13], v[40:41] op_sel:[1,1,0] op_sel_hi:[0,1,1] neg_lo:[1,0,0]
    v_cvt_pk_bf16_f32 v43, v40, v41
    ds_write_b32 v1, v43 offset:9360
    v_pk_mul_f32 v[38:39], v[32:33], v[14:15] op_sel:[0,0] op_sel_hi:[1,0]
    v_pk_fma_f32 v[38:39], v[32:33], v[14:15], v[38:39] op_sel:[1,1,0] op_sel_hi:[0,1,1] neg_lo:[1,0,0]
    v_cvt_pk_bf16_f32 v44, v38, v39
    ds_write_b32 v1, v44 offset:10400
    v_pk_mul_f32 v[40:41], v[32:33], v[16:17] op_sel:[0,0] op_sel_hi:[1,0]
    v_pk_fma_f32 v[40:41], v[32:33], v[16:17], v[40:41] op_sel:[1,1,0] op_sel_hi:[0,1,1] neg_lo:[1,0,0]
    v_cvt_pk_bf16_f32 v45, v40, v41
    ds_write_b32 v1, v45 offset:11440
    v_pk_mul_f32 v[38:39], v[32:33], v[18:19] op_sel:[0,0] op_sel_hi:[1,0]
    v_pk_fma_f32 v[38:39], v[32:33], v[18:19], v[38:39] op_sel:[1,1,0] op_sel_hi:[0,1,1] neg_lo:[1,0,0]
    v_cvt_pk_bf16_f32 v42, v38, v39
    ds_write_b32 v1, v42 offset:12480
    v_pk_mul_f32 v[40:41], v[32:33], v[20:21] op_sel:[0,0] op_sel_hi:[1,0]
    v_pk_fma_f32 v[40:41], v[32:33], v[20:21], v[40:41] op_sel:[1,1,0] op_sel_hi:[0,1,1] neg_lo:[1,0,0]
    v_cvt_pk_bf16_f32 v43, v40, v41
    ds_write_b32 v1, v43 offset:13520
    v_pk_mul_f32 v[38:39], v[32:33], v[22:23] op_sel:[0,0] op_sel_hi:[1,0]
    v_pk_fma_f32 v[38:39], v[32:33], v[22:23], v[38:39] op_sel:[1,1,0] op_sel_hi:[0,1,1] neg_lo:[1,0,0]
    v_cvt_pk_bf16_f32 v44, v38, v39
    ds_write_b32 v1, v44 offset:14560
    v_pk_mul_f32 v[40:41], v[32:33], v[24:25] op_sel:[0,0] op_sel_hi:[1,0]
    v_pk_fma_f32 v[40:41], v[32:33], v[24:25], v[40:41] op_sel:[1,1,0] op_sel_hi:[0,1,1] neg_lo:[1,0,0]
    v_cvt_pk_bf16_f32 v45, v40, v41
    ds_write_b32 v1, v45 offset:15600
    v_pk_mul_f32 v[30:31], v[32:33], v[28:29] op_sel:[0,0] op_sel_hi:[1,0]
    v_pk_fma_f32 v[30:31], v[32:33], v[28:29], v[30:31] op_sel:[1,1,0] op_sel_hi:[0,1,1] neg_lo:[1,0,0]
    v_cvt_pk_bf16_f32 v42, v30, v31
    ds_write_b32 v1, v42 offset:16640
    v_pk_mul_f32 v[38:39], v[30:31], v[14:15] op_sel:[0,0] op_sel_hi:[1,0]
    v_pk_fma_f32 v[38:39], v[30:31], v[14:15], v[38:39] op_sel:[1,1,0] op_sel_hi:[0,1,1] neg_lo:[1,0,0]
    v_cvt_pk_bf16_f32 v43, v38, v39
    ds_write_b32 v1, v43 offset:17680
    v_pk_mul_f32 v[40:41], v[30:31], v[18:19] op_sel:[0,0] op_sel_hi:[1,0]
    v_pk_fma_f32 v[40:41], v[30:31], v[18:19], v[40:41] op_sel:[1,1,0] op_sel_hi:[0,1,1] neg_lo:[1,0,0]
    v_cvt_pk_bf16_f32 v44, v40, v41
    ds_write_b32 v1, v44 offset:18720
    v_pk_mul_f32 v[38:39], v[30:31], v[22:23] op_sel:[0,0] op_sel_hi:[1,0]
    v_pk_fma_f32 v[38:39], v[30:31], v[22:23], v[38:39] op_sel:[1,1,0] op_sel_hi:[0,1,1] neg_lo:[1,0,0]
    v_cvt_pk_bf16_f32 v45, v38, v39
    ds_write_b32 v1, v45 offset:19760
    v_pk_mul_f32 v[32:33], v[30:31], v[28:29] op_sel:[0,0] op_sel_hi:[1,0]
    v_pk_fma_f32 v[32:33], v[30:31], v[28:29], v[32:33] op_sel:[1,1,0] op_sel_hi:[0,1,1] neg_lo:[1,0,0]
    v_cvt_pk_bf16_f32 v42, v32, v33
    ds_write_b32 v1, v42 offset:20800
    v_pk_mul_f32 v[40:41], v[32:33], v[14:15] op_sel:[0,0] op_sel_hi:[1,0]
    v_pk_fma_f32 v[40:41], v[32:33], v[14:15], v[40:41] op_sel:[1,1,0] op_sel_hi:[0,1,1] neg_lo:[1,0,0]
    v_cvt_pk_bf16_f32 v43, v40, v41
    ds_write_b32 v1, v43 offset:21840
    v_pk_mul_f32 v[38:39], v[32:33], v[18:19] op_sel:[0,0] op_sel_hi:[1,0]
    v_pk_fma_f32 v[38:39], v[32:33], v[18:19], v[38:39] op_sel:[1,1,0] op_sel_hi:[0,1,1] neg_lo:[1,0,0]
    v_cvt_pk_bf16_f32 v44, v38, v39
    ds_write_b32 v1, v44 offset:22880
    v_pk_mul_f32 v[40:41], v[32:33], v[22:23] op_sel:[0,0] op_sel_hi:[1,0]
    v_pk_fma_f32 v[40:41], v[32:33], v[22:23], v[40:41] op_sel:[1,1,0] op_sel_hi:[0,1,1] neg_lo:[1,0,0]
    v_cvt_pk_bf16_f32 v45, v40, v41
    ds_write_b32 v1, v45 offset:23920
    v_pk_mul_f32 v[30:31], v[32:33], v[28:29] op_sel:[0,0] op_sel_hi:[1,0]
    v_pk_fma_f32 v[30:31], v[32:33], v[28:29], v[30:31] op_sel:[1,1,0] op_sel_hi:[0,1,1] neg_lo:[1,0,0]
    v_cvt_pk_bf16_f32 v42, v30, v31
    ds_write_b32 v1, v42 offset:24960
    v_pk_mul_f32 v[38:39], v[30:31], v[18:19] op_sel:[0,0] op_sel_hi:[1,0]
    v_pk_fma_f32 v[38:39], v[30:31], v[18:19], v[38:39] op_sel:[1,1,0] op_sel_hi:[0,1,1] neg_lo:[1,0,0]
    v_cvt_pk_bf16_f32 v43, v38, v39
    ds_write_b32 v1, v43 offset:29120
    v_pk_mul_f32 v[32:33], v[30:31], v[28:29] op_sel:[0,0] op_sel_hi:[1,0]
    v_pk_fma_f32 v[32:33], v[30:31], v[28:29], v[32:33] op_sel:[1,1,0] op_sel_hi:[0,1,1] neg_lo:[1,0,0]
    v_cvt_pk_bf16_f32 v44, v32, v33
    ds_write_b32 v1, v44 offset:26000
    v_pk_mul_f32 v[40:41], v[32:33], v[18:19] op_sel:[0,0] op_sel_hi:[1,0]
    v_pk_fma_f32 v[40:41], v[32:33], v[18:19], v[40:41] op_sel:[1,1,0] op_sel_hi:[0,1,1] neg_lo:[1,0,0]
    v_cvt_pk_bf16_f32 v45, v40, v41
    ds_write_b32 v1, v45 offset:30160
    v_pk_mul_f32 v[30:31], v[32:33], v[28:29] op_sel:[0,0] op_sel_hi:[1,0]
    v_pk_fma_f32 v[30:31], v[32:33], v[28:29], v[30:31] op_sel:[1,1,0] op_sel_hi:[0,1,1] neg_lo:[1,0,0]
    v_cvt_pk_bf16_f32 v42, v30, v31
    ds_write_b32 v1, v42 offset:27040
    v_pk_mul_f32 v[38:39], v[30:31], v[18:19] op_sel:[0,0] op_sel_hi:[1,0]
    v_pk_fma_f32 v[38:39], v[30:31], v[18:19], v[38:39] op_sel:[1,1,0] op_sel_hi:[0,1,1] neg_lo:[1,0,0]
    v_cvt_pk_bf16_f32 v43, v38, v39
    ds_write_b32 v1, v43 offset:31200
    v_pk_mul_f32 v[32:33], v[30:31], v[28:29] op_sel:[0,0] op_sel_hi:[1,0]
    v_pk_fma_f32 v[32:33], v[30:31], v[28:29], v[32:33] op_sel:[1,1,0] op_sel_hi:[0,1,1] neg_lo:[1,0,0]
    v_cvt_pk_bf16_f32 v44, v32, v33
    ds_write_b32 v1, v44 offset:28080
    v_pk_mul_f32 v[40:41], v[32:33], v[18:19] op_sel:[0,0] op_sel_hi:[1,0]
    v_pk_fma_f32 v[40:41], v[32:33], v[18:19], v[40:41] op_sel:[1,1,0] op_sel_hi:[0,1,1] neg_lo:[1,0,0]
    v_cvt_pk_bf16_f32 v45, v40, v41
    ds_write_b32 v1, v45 offset:32240
    v_pk_mul_f32 v[30:31], v[32:33], v[28:29] op_sel:[0,0] op_sel_hi:[1,0]
    v_pk_fma_f32 v[30:31], v[32:33], v[28:29], v[30:31] op_sel:[1,1,0] op_sel_hi:[0,1,1] neg_lo:[1,0,0]
    v_cvt_pk_bf16_f32 v42, v30, v31
    ds_write_b32 v1, v42 offset:33280
    v_pk_mul_f32 v[32:33], v[30:31], v[28:29] op_sel:[0,0] op_sel_hi:[1,0]
    v_pk_fma_f32 v[32:33], v[30:31], v[28:29], v[32:33] op_sel:[1,1,0] op_sel_hi:[0,1,1] neg_lo:[1,0,0]
    v_cvt_pk_bf16_f32 v43, v32, v33
    ds_write_b32 v1, v43 offset:34320
    v_pk_mul_f32 v[30:31], v[32:33], v[28:29] op_sel:[0,0] op_sel_hi:[1,0]
    v_pk_fma_f32 v[30:31], v[32:33], v[28:29], v[30:31] op_sel:[1,1,0] op_sel_hi:[0,1,1] neg_lo:[1,0,0]
    v_cvt_pk_bf16_f32 v44, v30, v31
    ds_write_b32 v1, v44 offset:35360
    v_pk_mul_f32 v[32:33], v[30:31], v[28:29] op_sel:[0,0] op_sel_hi:[1,0]
    v_pk_fma_f32 v[32:33], v[30:31], v[28:29], v[32:33] op_sel:[1,1,0] op_sel_hi:[0,1,1] neg_lo:[1,0,0]
    v_cvt_pk_bf16_f32 v45, v32, v33
    ds_write_b32 v1, v45 offset:36400
    v_pk_mul_f32 v[30:31], v[32:33], v[28:29] op_sel:[0,0] op_sel_hi:[1,0]
    v_pk_fma_f32 v[30:31], v[32:33], v[28:29], v[30:31] op_sel:[1,1,0] op_sel_hi:[0,1,1] neg_lo:[1,0,0]
    v_cvt_pk_bf16_f32 v42, v30, v31
    ds_write_b32 v1, v42 offset:37440
    v_pk_mul_f32 v[32:33], v[30:31], v[28:29] op_sel:[0,0] op_sel_hi:[1,0]
    v_pk_fma_f32 v[32:33], v[30:31], v[28:29], v[32:33] op_sel:[1,1,0] op_sel_hi:[0,1,1] neg_lo:[1,0,0]
    v_cvt_pk_bf16_f32 v43, v32, v33
    ds_write_b32 v1, v43 offset:38480
    v_pk_mul_f32 v[30:31], v[32:33], v[28:29] op_sel:[0,0] op_sel_hi:[1,0]
    v_pk_fma_f32 v[30:31], v[32:33], v[28:29], v[30:31] op_sel:[1,1,0] op_sel_hi:[0,1,1] neg_lo:[1,0,0]
    v_cvt_pk_bf16_f32 v44, v30, v31
    ds_write_b32 v1, v44 offset:39520
    v_pk_mul_f32 v[32:33], v[30:31], v[28:29] op_sel:[0,0] op_sel_hi:[1,0]
    v_pk_fma_f32 v[32:33], v[30:31], v[28:29], v[32:33] op_sel:[1,1,0] op_sel_hi:[0,1,1] neg_lo:[1,0,0]
    v_cvt_pk_bf16_f32 v45, v32, v33
    ds_write_b32 v1, v45 offset:40560
    v_pk_mul_f32 v[30:31], v[32:33], v[28:29] op_sel:[0,0] op_sel_hi:[1,0]
    v_pk_fma_f32 v[30:31], v[32:33], v[28:29], v[30:31] op_sel:[1,1,0] op_sel_hi:[0,1,1] neg_lo:[1,0,0]
    v_cvt_pk_bf16_f32 v42, v30, v31
    ds_write_b32 v1, v42 offset:41600
    ds_write_b16 v118, v120 offset:42640
    ds_write_b16_d16_hi v118, v120 offset:42720
    ds_write_b16 v118, v121 offset:42800
    ds_write_b16_d16_hi v118, v121 offset:42880
    ds_write_b16 v118, v122 offset:42960
    ds_write_b16_d16_hi v118, v122 offset:43040
    ds_write_b16 v118, v123 offset:43120
    ds_write_b16_d16_hi v118, v123 offset:43200
    s_waitcnt lgkmcnt(0)
    s_barrier
    ds_read_b128 v[120:123], v119 offset:42640
    s_waitcnt lgkmcnt(0)
    buffer_store_dwordx4 v[120:123], v116, s[64:67], s68 offen sc1
    v_lshrrev_b32 v50, 6, v0
    s_nop 0
    v_readfirstlane_b32 s22, v50
    s_nop 3
    s_cmp_ge_u32 s22, 3
    s_cbranch_scc1 K1_KG_SKIP
    v_and_b32 v51, 15, v0
    v_bfe_u32 v52, v0, 4, 2
    s_movk_i32 s23, 1040
    v_mul_u32_u24 v53, 1040, v51
    v_lshl_add_u32 v53, v52, 4, v53
    s_mul_i32 s23, s22, 16640
    v_add_u32 v54, s23, v53
    v_add_u32 v55, 49920, v53
    ds_read_b128 v[96:99], v54 offset:0
    ds_read_b128 v[100:103], v55 offset:0
    ds_read_b128 v[104:107], v54 offset:64
    ds_read_b128 v[108:111], v55 offset:64
    ds_read_b128 v[112:115], v54 offset:128
    ds_read_b128 v[116:119], v55 offset:128
    ds_read_b128 v[120:123], v54 offset:192
    ds_read_b128 v[124:127], v55 offset:192
    ds_read_b128 v[128:131], v54 offset:256
    ds_read_b128 v[132:135], v55 offset:256
    ds_read_b128 v[136:139], v54 offset:320
    ds_read_b128 v[140:143], v55 offset:320
    ds_read_b128 v[144:147], v54 offset:384
    ds_read_b128 v[148:151], v55 offset:384
    ds_read_b128 v[152:155], v54 offset:448
    ds_read_b128 v[156:159], v55 offset:448
    s_waitcnt lgkmcnt(8)
    v_mfma_f32_16x16x32_bf16 v[56:59], v[96:99], v[100:103], 0
    v_mfma_f32_16x16x32_bf16 v[56:59], v[104:107], v[108:111], v[56:59]
    v_mfma_f32_16x16x32_bf16 v[56:59], v[112:115], v[116:119], v[56:59]
    v_mfma_f32_16x16x32_bf16 v[56:59], v[120:123], v[124:127], v[56:59]
    ds_read_b128 v[96:99], v54 offset:512
    ds_read_b128 v[100:103], v55 offset:512
    ds_read_b128 v[104:107], v54 offset:576
    ds_read_b128 v[108:111], v55 offset:576
    ds_read_b128 v[112:115], v54 offset:640
    ds_read_b128 v[116:119], v55 offset:640
    ds_read_b128 v[120:123], v54 offset:704
    ds_read_b128 v[124:127], v55 offset:704
    s_waitcnt lgkmcnt(8)
    v_mfma_f32_16x16x32_bf16 v[56:59], v[128:131], v[132:135], v[56:59]
    v_mfma_f32_16x16x32_bf16 v[56:59], v[136:139], v[140:143], v[56:59]
    v_mfma_f32_16x16x32_bf16 v[56:59], v[144:147], v[148:151], v[56:59]
    v_mfma_f32_16x16x32_bf16 v[56:59], v[152:155], v[156:159], v[56:59]
    ds_read_b128 v[128:131], v54 offset:768
    ds_read_b128 v[132:135], v55 offset:768
    ds_read_b128 v[136:139], v54 offset:832
    ds_read_b128 v[140:143], v55 offset:832
    ds_read_b128 v[144:147], v54 offset:896
    ds_read_b128 v[148:151], v55 offset:896
    ds_read_b128 v[152:155], v54 offset:960
    ds_read_b128 v[156:159], v55 offset:960
    s_waitcnt lgkmcnt(8)
    v_mfma_f32_16x16x32_bf16 v[56:59], v[96:99], v[100:103], v[56:59]
    v_mfma_f32_16x16x32_bf16 v[56:59], v[104:107], v[108:111], v[56:59]
    v_mfma_f32_16x16x32_bf16 v[56:59], v[112:115], v[116:119], v[56:59]
    v_mfma_f32_16x16x32_bf16 v[56:59], v[120:123], v[124:127], v[56:59]
    s_waitcnt lgkmcnt(0)
    v_mfma_f32_16x16x32_bf16 v[56:59], v[128:131], v[132:135], v[56:59]
    v_mfma_f32_16x16x32_bf16 v[56:59], v[136:139], v[140:143], v[56:59]
    v_mfma_f32_16x16x32_bf16 v[56:59], v[144:147], v[148:151], v[56:59]
    v_mfma_f32_16x16x32_bf16 v[56:59], v[152:155], v[156:159], v[56:59]
    v_cmp_gt_u32 vcc, 2, v52
    s_cmp_eq_u32 s22, 0
    s_cbranch_scc0 K1_T1
    v_lshrrev_b32 v60, 1, v52
    v_lshlrev_b32 v60, 7, v60
    v_and_b32 v61, 1, v52
    v_lshl_add_u32 v60, v61, 2, v60
    v_mov_b32 v61, 1
    s_branch K1_TD
K1_T1:
    s_cmp_eq_u32 s22, 1
    s_cbranch_scc0 K1_T2
    v_lshlrev_b32 v60, 7, v52
    v_add_u32 v60, 256, v60
    v_lshlrev_b32 v61, 2, v52
    v_add_u32 v61, 504, v61
    v_cndmask_b32 v60, v61, v60, vcc
    v_mov_b32 v61, 128
    v_mov_b32 v62, 2
    v_cndmask_b32 v61, v61, v62, vcc
    s_branch K1_TD
K1_T2:
    v_lshlrev_b32 v60, 9, v52
    v_add_u32 v60, 1024, v60
    v_lshlrev_b32 v61, 3, v52
    v_add_u32 v61, 2032, v61
    v_cndmask_b32 v60, v61, v60, vcc
    v_mov_b32 v61, 1
    v_mov_b32 v62, 128
    v_cndmask_b32 v61, v61, v62, vcc
K1_TD:
    v_lshl_add_u32 v60, v51, 3, v60
    v_lshlrev_b32 v60, 2, v60
    v_add_u32 v60, 66560, v60
    v_lshlrev_b32 v61, 2, v61
    s_nop 7
    ds_write_b32 v60, v56
    v_add_u32 v60, v60, v61
    ds_write_b32 v60, v57
    v_add_u32 v60, v60, v61
    ds_write_b32 v60, v58
    v_add_u32 v60, v60, v61
    ds_write_b32 v60, v59
K1_KG_SKIP:
    s_waitcnt lgkmcnt(0)
    s_barrier
    s_mul_i32 s23, s3, 4608
    v_lshlrev_b32 v50, 4, v0
    ds_read_b32 v96, v64
    ds_read_b32 v97, v65
    ds_read_b32 v98, v66
    ds_read_b32 v99, v67
    ds_read_b32 v100, v68
    ds_read_b32 v101, v69
    ds_read_b32 v102, v70
    ds_read_b32 v103, v71
    s_waitcnt lgkmcnt(0)
    v_cvt_pk_bf16_f32 v108, v96, v97
    v_cvt_pk_bf16_f32 v109, v98, v99
    v_cvt_pk_bf16_f32 v110, v100, v101
    v_cvt_pk_bf16_f32 v111, v102, v103
    buffer_store_dwordx4 v[108:111], v50, s[52:55], s23 offen sc1
    s_cmp_eq_u32 s22, 0
    s_cbranch_scc0 K1_END
    v_and_b32 v52, 31, v0
    v_lshlrev_b32 v52, 4, v52
    v_add_u32 v52, 4096, v52
    s_nop 1
    s_nop 1
    ds_read_b32 v96, v74
    ds_read_b32 v97, v75
    ds_read_b32 v98, v76
    ds_read_b32 v99, v77
    ds_read_b32 v100, v78
    ds_read_b32 v101, v79
    ds_read_b32 v102, v80
    ds_read_b32 v103, v81
    s_waitcnt lgkmcnt(0)
    v_cvt_pk_bf16_f32 v108, v96, v97
    v_cvt_pk_bf16_f32 v109, v98, v99
    v_cvt_pk_bf16_f32 v110, v100, v101
    v_cvt_pk_bf16_f32 v111, v102, v103
    buffer_store_dwordx4 v[108:111], v52, s[52:55], s23 offen sc1
K1_END:
    s_endpgm
.globl k2_kernel
.p2align 8
.type k2_kernel,@function
k2_kernel:
    s_cmp_ge_u32 s2, 504
    s_cbranch_scc1 K2_END
    s_load_dwordx2 s[6:7], s[0:1], 120
    s_cmp_ge_u32 s2, 448
    s_cbranch_scc1 K2_CS
    s_load_dwordx2 s[4:5], s[0:1], 64
    s_load_dwordx2 s[42:43], s[0:1], 0
    s_load_dwordx2 s[40:41], s[0:1], 96
    v_lshrrev_b32 v1, 6, v0
    v_and_b32 v2, 63, v0
    s_nop 0
    v_readfirstlane_b32 s3, v1
    v_lshlrev_b32 v3, 4, v2
    v_lshlrev_b32 v4, 4, v0
    s_waitcnt lgkmcnt(0)
    s_add_u32 s8, s6, 3899392
    s_addc_u32 s9, s7, 0
    s_mov_b32 s10, 2064384
    s_mov_b32 s11, 0x00020000
    s_mov_b32 s12, s6
    s_mov_b32 s13, s7
    s_mov_b32 s14, 1949696
    s_mov_b32 s15, 0x00020000
    s_add_u32 s16, s6, 1949696
    s_addc_u32 s17, s7, 0
    s_mov_b32 s18, 1949696
    s_mov_b32 s19, 0x00020000
    s_add_u32 s20, s6, 5963776
    s_addc_u32 s21, s7, 0
    s_mov_b32 s22, 1949696
    s_mov_b32 s23, 0x00020000
    s_mov_b32 s24, s4
    s_mov_b32 s25, s5
    s_mov_b32 s26, 896
    s_mov_b32 s27, 0x00020000
    s_mul_i32 s30, s2, 4608
    s_mul_i32 s31, s2, 4352
    s_mul_i32 s32, s2, 4352
    s_lshl_b32 s33, s2, 1
    buffer_load_dwordx4 v[96:99], v4, s[8:11], s30 offen
    buffer_load_dwordx4 v[100:103], v4, s[8:11], s30 offen offset:16
    v_and_b32 v21, 15, v0
    v_lshlrev_b32 v21, 4, v21
    v_add_u32 v22, 4096, v21
    s_cmp_eq_u32 s3, 0
    s_cbranch_scc0 K2_NK2
    buffer_load_dwordx4 v[128:131], v22, s[8:11], s30 offen
    buffer_load_dwordx4 v[132:135], v22, s[8:11], s30 offen offset:16
K2_NK2:
    v_lshrrev_b32 v13, 3, v2
    v_lshrrev_b32 v14, 1, v13
    s_and_b32 s34, s3, 1
    s_lshl_b32 s34, s34, 2
    v_or_b32 v14, s34, v14
    v_and_b32 v15, 7, v2
    v_xor_b32 v14, v14, v15
    v_lshlrev_b32 v14, 4, v14
    v_lshl_add_u32 v14, v13, 7, v14
    s_lshl_b32 s34, s3, 10
    s_add_u32 s35, s34, 35328
    s_add_u32 s34, s34, s31
    s_mov_b32 m0, s35
    s_nop 0
    buffer_load_dwordx4 v14, s[12:15], s34 offen lds
    buffer_load_dwordx4 v[8:11], v4, s[16:19], s32 offen
    v_mov_b32 v5, 0
    buffer_load_ushort v12, v5, s[24:27], s33 offen
    s_mov_b32 s44, s40
    s_mov_b32 s45, s41
    s_mov_b32 s46, 1605632
    s_mov_b32 s47, 0x00020000
    s_mul_i32 s50, s2, 3584
    v_cmp_gt_u32 vcc, 224, v0
    s_and_saveexec_b64 s[48:49], vcc
    s_cbranch_execz K2_NOT
    buffer_load_dwordx4 v[144:147], v4, s[44:47], s50 offen
K2_NOT:
    s_mov_b64 exec, -1
    v_mov_b32 v16, 0
    v_mov_b32 v17, 0
    v_mov_b32 v18, 0
    v_mov_b32 v19, 0
    ds_write_b128 v4, v[16:19] offset:39424
    ds_write_b128 v4, v[16:19] offset:43520
    s_cmp_eq_u32 s3, 0
    s_cbranch_scc1 K2_C0
    s_waitcnt vmcnt(4)
    s_branch K2_C1
K2_C0:
    s_waitcnt vmcnt(4)
K2_C1:
    v_mov_b32 v104, v97
    v_mov_b32 v105, v98
    v_mov_b32 v106, v99
    v_mov_b32 v107, v100
    v_mov_b32 v108, v101
    v_mov_b32 v109, v102
    v_mov_b32 v110, v103
    v_alignbit_b32 v112, v97, v96, 16
    v_alignbit_b32 v113, v98, v97, 16
    v_alignbit_b32 v114, v99, v98, 16
    v_alignbit_b32 v115, v100, v99, 16
    v_alignbit_b32 v116, v101, v100, 16
    v_alignbit_b32 v117, v102, v101, 16
    v_alignbit_b32 v120, v98, v97, 16
    v_alignbit_b32 v121, v99, v98, 16
    v_alignbit_b32 v122, v100, v99, 16
    v_alignbit_b32 v123, v101, v100, 16
    v_alignbit_b32 v124, v102, v101, 16
    v_alignbit_b32 v125, v103, v102, 16
    ds_write_b128 v4, v[96:99] offset:0
    ds_write_b128 v4, v[112:115] offset:4416
    ds_write_b128 v4, v[104:107] offset:8832
    ds_write_b128 v4, v[120:123] offset:13248
    ds_write_b128 v4, v[98:101] offset:17664
    ds_write_b128 v4, v[114:117] offset:22080
    ds_write_b128 v4, v[106:109] offset:26496
    ds_write_b128 v4, v[122:125] offset:30912
    s_cmp_eq_u32 s3, 0
    s_cbranch_scc0 K2_NC2
    s_nop 1
    v_mov_b32 v104, v129
    v_mov_b32 v105, v130
    v_mov_b32 v106, v131
    v_mov_b32 v107, v132
    v_mov_b32 v108, v133
    v_mov_b32 v109, v134
    v_mov_b32 v110, v135
    v_alignbit_b32 v112, v129, v128, 16
    v_alignbit_b32 v113, v130, v129, 16
    v_alignbit_b32 v114, v131, v130, 16
    v_alignbit_b32 v115, v132, v131, 16
    v_alignbit_b32 v116, v133, v132, 16
    v_alignbit_b32 v117, v134, v133, 16
    v_alignbit_b32 v120, v130, v129, 16
    v_alignbit_b32 v121, v131, v130, 16
    v_alignbit_b32 v122, v132, v131, 16
    v_alignbit_b32 v123, v133, v132, 16
    v_alignbit_b32 v124, v134, v133, 16
    v_alignbit_b32 v125, v135, v134, 16
    ds_write_b128 v22, v[128:131] offset:0
    ds_write_b128 v22, v[112:115] offset:4416
    ds_write_b128 v22, v[104:107] offset:8832
    ds_write_b128 v22, v[120:123] offset:13248
    ds_write_b128 v22, v[130:133] offset:17664
    ds_write_b128 v22, v[114:117] offset:22080
    ds_write_b128 v22, v[106:109] offset:26496
    ds_write_b128 v22, v[122:125] offset:30912
K2_NC2:
    v_and_b32 v6, 31, v2
    v_lshrrev_b32 v7, 5, v2
    v_and_b32 v13, 7, v6
    v_mul_u32_u24 v14, 4416, v13
    v_sub_u32 v13, v6, v13
    v_lshl_add_u32 v14, v13, 1, v14
    v_lshl_add_u32 v14, v7, 4, v14
    v_sub_u32 v16, 31, v6
    s_waitcnt vmcnt(0) lgkmcnt(0)
    s_barrier
    s_cmp_eq_u32 s3, 0
    s_cbranch_scc0 K2_W1
    ds_read_b128 v[64:67], v14 offset:0
    ds_read_b128 v[68:71], v14 offset:32
    ds_read_b128 v[72:75], v14 offset:64
    v_add_u32 v17, 0, v16
    v_bfe_u32 v18, v17, 1, 3
    v_xor_b32 v18, v18, v7
    v_lshlrev_b32 v17, 7, v17
    v_lshl_add_u32 v15, v18, 4, v17
    ds_read_b128 v[96:99], v15 offset:35328
    ds_read_b128 v[76:79], v14 offset:96
    v_xor_b32 v19, 32, v15
    ds_read_b128 v[100:103], v19 offset:35328
    ds_read_b128 v[80:83], v14 offset:128
    v_xor_b32 v20, 64, v15
    ds_read_b128 v[104:107], v20 offset:35328
    s_waitcnt lgkmcnt(4)
    v_mfma_f32_32x32x16_bf16 v[32:47], v[64:67], v[96:99], 0
    v_mfma_f32_32x32x16_bf16 v[48:63], v[72:75], v[96:99], 0
    ds_read_b128 v[84:87], v14 offset:160
    v_xor_b32 v21, 96, v15
    ds_read_b128 v[108:111], v21 offset:35328
    s_waitcnt lgkmcnt(4)
    v_mfma_f32_32x32x16_bf16 v[32:47], v[68:71], v[100:103], v[32:47]
    v_mfma_f32_32x32x16_bf16 v[48:63], v[76:79], v[100:103], v[48:63]
    ds_read_b128 v[88:91], v14 offset:192
    v_add_u32 v17, 1, v16
    v_bfe_u32 v18, v17, 1, 3
    v_xor_b32 v18, v18, v7
    v_lshlrev_b32 v17, 7, v17
    v_lshl_add_u32 v15, v18, 4, v17
    ds_read_b128 v[96:99], v15 offset:35328
    s_waitcnt lgkmcnt(4)
    v_mfma_f32_32x32x16_bf16 v[32:47], v[72:75], v[104:107], v[32:47]
    v_mfma_f32_32x32x16_bf16 v[48:63], v[80:83], v[104:107], v[48:63]
    ds_read_b128 v[92:95], v14 offset:224
    v_xor_b32 v19, 32, v15
    ds_read_b128 v[100:103], v19 offset:35328
    s_waitcnt lgkmcnt(4)
    v_mfma_f32_32x32x16_bf16 v[32:47], v[76:79], v[108:111], v[32:47]
    v_mfma_f32_32x32x16_bf16 v[48:63], v[84:87], v[108:111], v[48:63]
    ds_read_b128 v[64:67], v14 offset:256
    v_xor_b32 v20, 64, v15
    ds_read_b128 v[104:107], v20 offset:35328
    s_waitcnt lgkmcnt(4)
    v_mfma_f32_32x32x16_bf16 v[32:47], v[80:83], v[96:99], v[32:47]
    v_mfma_f32_32x32x16_bf16 v[48:63], v[88:91], v[96:99], v[48:63]
    ds_read_b128 v[68:71], v14 offset:288
    v_xor_b32 v21, 96, v15
    ds_read_b128 v[108:111], v21 offset:35328
    s_waitcnt lgkmcnt(4)
    v_mfma_f32_32x32x16_bf16 v[32:47], v[84:87], v[100:103], v[32:47]
    v_mfma_f32_32x32x16_bf16 v[48:63], v[92:95], v[100:103], v[48:63]
    ds_read_b128 v[72:75], v14 offset:320
    v_add_u32 v17, 2, v16
    v_bfe_u32 v18, v17, 1, 3
    v_xor_b32 v18, v18, v7
    v_lshlrev_b32 v17, 7, v17
    v_lshl_add_u32 v15, v18, 4, v17
    ds_read_b128 v[96:99], v15 offset:35328
    s_waitcnt lgkmcnt(4)
    v_mfma_f32_32x32x16_bf16 v[32:47], v[88:91], v[104:107], v[32:47]
    v_mfma_f32_32x32x16_bf16 v[48:63], v[64:67], v[104:107], v[48:63]
    ds_read_b128 v[76:79], v14 offset:352
    v_xor_b32 v19, 32, v15
    ds_read_b128 v[100:103], v19 offset:35328
    s_waitcnt lgkmcnt(4)
    v_mfma_f32_32x32x16_bf16 v[32:47], v[92:95], v[108:111], v[32:47]
    v_mfma_f32_32x32x16_bf16 v[48:63], v[68:71], v[108:111], v[48:63]
    ds_read_b128 v[80:83], v14 offset:384
    v_xor_b32 v20, 64, v15
    ds_read_b128 v[104:107], v20 offset:35328
    s_waitcnt lgkmcnt(4)
    v_mfma_f32_32x32x16_bf16 v[32:47], v[64:67], v[96:99], v[32:47]
    v_mfma_f32_32x32x16_bf16 v[48:63], v[72:75], v[96:99], v[48:63]
    ds_read_b128 v[84:87], v14 offset:416
    v_xor_b32 v21, 96, v15
    ds_read_b128 v[108:111], v21 offset:35328
    s_waitcnt lgkmcnt(4)
    v_mfma_f32_32x32x16_bf16 v[32:47], v[68:71], v[100:103], v[32:47]
    v_mfma_f32_32x32x16_bf16 v[48:63], v[76:79], v[100:103], v[48:63]
    ds_read_b128 v[88:91], v14 offset:448
    v_add_u32 v17, 3, v16
    v_bfe_u32 v18, v17, 1, 3
    v_xor_b32 v18, v18, v7
    v_lshlrev_b32 v17, 7, v17
    v_lshl_add_u32 v15, v18, 4, v17
    ds_read_b128 v[96:99], v15 offset:35328
    s_waitcnt lgkmcnt(4)
    v_mfma_f32_32x32x16_bf16 v[32:47], v[72:75], v[104:107], v[32:47]
    v_mfma_f32_32x32x16_bf16 v[48:63], v[80:83], v[104:107], v[48:63]
    ds_read_b128 v[92:95], v14 offset:480
    v_xor_b32 v19, 32, v15
    ds_read_b128 v[100:103], v19 offset:35328
    s_waitcnt lgkmcnt(4)
    v_mfma_f32_32x32x16_bf16 v[32:47], v[76:79], v[108:111], v[32:47]
    v_mfma_f32_32x32x16_bf16 v[48:63], v[84:87], v[108:111], v[48:63]
    ds_read_b128 v[64:67], v14 offset:512
    v_xor_b32 v20, 64, v15
    ds_read_b128 v[104:107], v20 offset:35328
    s_waitcnt lgkmcnt(4)
    v_mfma_f32_32x32x16_bf16 v[32:47], v[80:83], v[96:99], v[32:47]
    v_mfma_f32_32x32x16_bf16 v[48:63], v[88:91], v[96:99], v[48:63]
    ds_read_b128 v[68:71], v14 offset:544
    v_xor_b32 v21, 96, v15
    ds_read_b128 v[108:111], v21 offset:35328
    s_waitcnt lgkmcnt(4)
    v_mfma_f32_32x32x16_bf16 v[32:47], v[84:87], v[100:103], v[32:47]
    v_mfma_f32_32x32x16_bf16 v[48:63], v[92:95], v[100:103], v[48:63]
    ds_read_b128 v[72:75], v14 offset:576
    v_add_u32 v17, 4, v16
    v_bfe_u32 v18, v17, 1, 3
    v_xor_b32 v18, v18, v7
    v_lshlrev_b32 v17, 7, v17
    v_lshl_add_u32 v15, v18, 4, v17
    ds_read_b128 v[96:99], v15 offset:35328
    s_waitcnt lgkmcnt(4)
    v_mfma_f32_32x32x16_bf16 v[32:47], v[88:91], v[104:107], v[32:47]
    v_mfma_f32_32x32x16_bf16 v[48:63], v[64:67], v[104:107], v[48:63]
    ds_read_b128 v[76:79], v14 offset:608
    v_xor_b32 v19, 32, v15
    ds_read_b128 v[100:103], v19 offset:35328
    s_waitcnt lgkmcnt(4)
    v_mfma_f32_32x32x16_bf16 v[32:47], v[92:95], v[108:111], v[32:47]
    v_mfma_f32_32x32x16_bf16 v[48:63], v[68:71], v[108:111], v[48:63]
    ds_read_b128 v[80:83], v14 offset:640
    v_xor_b32 v20, 64, v15
    ds_read_b128 v[104:107], v20 offset:35328
    s_waitcnt lgkmcnt(4)
    v_mfma_f32_32x32x16_bf16 v[32:47], v[64:67], v[96:99], v[32:47]
    v_mfma_f32_32x32x16_bf16 v[48:63], v[72:75], v[96:99], v[48:63]
    ds_read_b128 v[84:87], v14 offset:672
    v_xor_b32 v21, 96, v15
    ds_read_b128 v[108:111], v21 offset:35328
    s_waitcnt lgkmcnt(4)
    v_mfma_f32_32x32x16_bf16 v[32:47], v[68:71], v[100:103], v[32:47]
    v_mfma_f32_32x32x16_bf16 v[48:63], v[76:79], v[100:103], v[48:63]
    ds_read_b128 v[88:91], v14 offset:704
    v_add_u32 v17, 5, v16
    v_bfe_u32 v18, v17, 1, 3
    v_xor_b32 v18, v18, v7
    v_lshlrev_b32 v17, 7, v17
    v_lshl_add_u32 v15, v18, 4, v17
    ds_read_b128 v[96:99], v15 offset:35328
    s_waitcnt lgkmcnt(4)
    v_mfma_f32_32x32x16_bf16 v[32:47], v[72:75], v[104:107], v[32:47]
    v_mfma_f32_32x32x16_bf16 v[48:63], v[80:83], v[104:107], v[48:63]
    ds_read_b128 v[92:95], v14 offset:736
    v_xor_b32 v19, 32, v15
    ds_read_b128 v[100:103], v19 offset:35328
    s_waitcnt lgkmcnt(4)
    v_mfma_f32_32x32x16_bf16 v[32:47], v[76:79], v[108:111], v[32:47]
    v_mfma_f32_32x32x16_bf16 v[48:63], v[84:87], v[108:111], v[48:63]
    ds_read_b128 v[64:67], v14 offset:768
    v_xor_b32 v20, 64, v15
    ds_read_b128 v[104:107], v20 offset:35328
    s_waitcnt lgkmcnt(4)
    v_mfma_f32_32x32x16_bf16 v[32:47], v[80:83], v[96:99], v[32:47]
    v_mfma_f32_32x32x16_bf16 v[48:63], v[88:91], v[96:99], v[48:63]
    ds_read_b128 v[68:71], v14 offset:800
    v_xor_b32 v21, 96, v15
    ds_read_b128 v[108:111], v21 offset:35328
    s_waitcnt lgkmcnt(4)
    v_mfma_f32_32x32x16_bf16 v[32:47], v[84:87], v[100:103], v[32:47]
    v_mfma_f32_32x32x16_bf16 v[48:63], v[92:95], v[100:103], v[48:63]
    ds_read_b128 v[72:75], v14 offset:832
    v_add_u32 v17, 6, v16
    v_bfe_u32 v18, v17, 1, 3
    v_xor_b32 v18, v18, v7
    v_lshlrev_b32 v17, 7, v17
    v_lshl_add_u32 v15, v18, 4, v17
    ds_read_b128 v[96:99], v15 offset:35328
    s_waitcnt lgkmcnt(4)
    v_mfma_f32_32x32x16_bf16 v[32:47], v[88:91], v[104:107], v[32:47]
    v_mfma_f32_32x32x16_bf16 v[48:63], v[64:67], v[104:107], v[48:63]
    ds_read_b128 v[76:79], v14 offset:864
    v_xor_b32 v19, 32, v15
    ds_read_b128 v[100:103], v19 offset:35328
    s_waitcnt lgkmcnt(4)
    v_mfma_f32_32x32x16_bf16 v[32:47], v[92:95], v[108:111], v[32:47]
    v_mfma_f32_32x32x16_bf16 v[48:63], v[68:71], v[108:111], v[48:63]
    ds_read_b128 v[80:83], v14 offset:896
    v_xor_b32 v20, 64, v15
    ds_read_b128 v[104:107], v20 offset:35328
    s_waitcnt lgkmcnt(4)
    v_mfma_f32_32x32x16_bf16 v[32:47], v[64:67], v[96:99], v[32:47]
    v_mfma_f32_32x32x16_bf16 v[48:63], v[72:75], v[96:99], v[48:63]
    ds_read_b128 v[84:87], v14 offset:928
    v_xor_b32 v21, 96, v15
    ds_read_b128 v[108:111], v21 offset:35328
    s_waitcnt lgkmcnt(4)
    v_mfma_f32_32x32x16_bf16 v[32:47], v[68:71], v[100:103], v[32:47]
    v_mfma_f32_32x32x16_bf16 v[48:63], v[76:79], v[100:103], v[48:63]
    ds_read_b128 v[88:91], v14 offset:960
    v_add_u32 v17, 7, v16
    v_bfe_u32 v18, v17, 1, 3
    v_xor_b32 v18, v18, v7
    v_lshlrev_b32 v17, 7, v17
    v_lshl_add_u32 v15, v18, 4, v17
    ds_read_b128 v[96:99], v15 offset:35328
    s_waitcnt lgkmcnt(4)
    v_mfma_f32_32x32x16_bf16 v[32:47], v[72:75], v[104:107], v[32:47]
    v_mfma_f32_32x32x16_bf16 v[48:63], v[80:83], v[104:107], v[48:63]
    ds_read_b128 v[92:95], v14 offset:992
    v_xor_b32 v19, 32, v15
    ds_read_b128 v[100:103], v19 offset:35328
    s_waitcnt lgkmcnt(4)
    v_mfma_f32_32x32x16_bf16 v[32:47], v[76:79], v[108:111], v[32:47]
    v_mfma_f32_32x32x16_bf16 v[48:63], v[84:87], v[108:111], v[48:63]
    ds_read_b128 v[64:67], v14 offset:1024
    v_xor_b32 v20, 64, v15
    ds_read_b128 v[104:107], v20 offset:35328
    s_waitcnt lgkmcnt(4)
    v_mfma_f32_32x32x16_bf16 v[32:47], v[80:83], v[96:99], v[32:47]
    v_mfma_f32_32x32x16_bf16 v[48:63], v[88:91], v[96:99], v[48:63]
    ds_read_b128 v[68:71], v14 offset:1056
    v_xor_b32 v21, 96, v15
    ds_read_b128 v[108:111], v21 offset:35328
    s_waitcnt lgkmcnt(4)
    v_mfma_f32_32x32x16_bf16 v[32:47], v[84:87], v[100:103], v[32:47]
    v_mfma_f32_32x32x16_bf16 v[48:63], v[92:95], v[100:103], v[48:63]
    ds_read_b128 v[72:75], v14 offset:1088
    v_add_u32 v17, 8, v16
    v_bfe_u32 v18, v17, 1, 3
    v_xor_b32 v18, v18, v7
    v_lshlrev_b32 v17, 7, v17
    v_lshl_add_u32 v15, v18, 4, v17
    ds_read_b128 v[96:99], v15 offset:35328
    s_waitcnt lgkmcnt(4)
    v_mfma_f32_32x32x16_bf16 v[32:47], v[88:91], v[104:107], v[32:47]
    v_mfma_f32_32x32x16_bf16 v[48:63], v[64:67], v[104:107], v[48:63]
    s_waitcnt lgkmcnt(2)
    v_mfma_f32_32x32x16_bf16 v[32:47], v[92:95], v[108:111], v[32:47]
    v_mfma_f32_32x32x16_bf16 v[48:63], v[68:71], v[108:111], v[48:63]
    s_waitcnt lgkmcnt(0)
    v_mfma_f32_32x32x16_bf16 v[32:47], v[64:67], v[96:99], v[32:47]
    v_mfma_f32_32x32x16_bf16 v[48:63], v[72:75], v[96:99], v[48:63]
    s_branch K2_RED
K2_W1:
    s_cmp_eq_u32 s3, 1
    s_cbranch_scc0 K2_W2
    ds_read_b128 v[68:71], v14 offset:1056
    ds_read_b128 v[72:75], v14 offset:1088
    ds_read_b128 v[76:79], v14 offset:1120
    v_add_u32 v17, 8, v16
    v_bfe_u32 v18, v17, 1, 3
    v_xor_b32 v18, v18, v7
    v_lshlrev_b32 v17, 7, v17
    v_lshl_add_u32 v15, v18, 4, v17
    v_xor_b32 v19, 32, v15
    ds_read_b128 v[100:103], v19 offset:35328
    ds_read_b128 v[80:83], v14 offset:1152
    v_xor_b32 v20, 64, v15
    ds_read_b128 v[104:107], v20 offset:35328
    ds_read_b128 v[84:87], v14 offset:1184
    v_xor_b32 v21, 96, v15
    ds_read_b128 v[108:111], v21 offset:35328
    s_waitcnt lgkmcnt(4)
    v_mfma_f32_32x32x16_bf16 v[32:47], v[68:71], v[100:103], 0
    v_mfma_f32_32x32x16_bf16 v[48:63], v[76:79], v[100:103], 0
    ds_read_b128 v[88:91], v14 offset:1216
    v_add_u32 v17, 9, v16
    v_bfe_u32 v18, v17, 1, 3
    v_xor_b32 v18, v18, v7
    v_lshlrev_b32 v17, 7, v17
    v_lshl_add_u32 v15, v18, 4, v17
    ds_read_b128 v[96:99], v15 offset:35328
    s_waitcnt lgkmcnt(4)
    v_mfma_f32_32x32x16_bf16 v[32:47], v[72:75], v[104:107], v[32:47]
    v_mfma_f32_32x32x16_bf16 v[48:63], v[80:83], v[104:107], v[48:63]
    ds_read_b128 v[92:95], v14 offset:1248
    v_xor_b32 v19, 32, v15
    ds_read_b128 v[100:103], v19 offset:35328
    s_waitcnt lgkmcnt(4)
    v_mfma_f32_32x32x16_bf16 v[32:47], v[76:79], v[108:111], v[32:47]
    v_mfma_f32_32x32x16_bf16 v[48:63], v[84:87], v[108:111], v[48:63]
    ds_read_b128 v[64:67], v14 offset:1280
    v_xor_b32 v20, 64, v15
    ds_read_b128 v[104:107], v20 offset:35328
    s_waitcnt lgkmcnt(4)
    v_mfma_f32_32x32x16_bf16 v[32:47], v[80:83], v[96:99], v[32:47]
    v_mfma_f32_32x32x16_bf16 v[48:63], v[88:91], v[96:99], v[48:63]
    ds_read_b128 v[68:71], v14 offset:1312
    v_xor_b32 v21, 96, v15
    ds_read_b128 v[108:111], v21 offset:35328
    s_waitcnt lgkmcnt(4)
    v_mfma_f32_32x32x16_bf16 v[32:47], v[84:87], v[100:103], v[32:47]
    v_mfma_f32_32x32x16_bf16 v[48:63], v[92:95], v[100:103], v[48:63]
    ds_read_b128 v[72:75], v14 offset:1344
    v_add_u32 v17, 10, v16
    v_bfe_u32 v18, v17, 1, 3
    v_xor_b32 v18, v18, v7
    v_lshlrev_b32 v17, 7, v17
    v_lshl_add_u32 v15, v18, 4, v17
    ds_read_b128 v[96:99], v15 offset:35328
    s_waitcnt lgkmcnt(4)
    v_mfma_f32_32x32x16_bf16 v[32:47], v[88:91], v[104:107], v[32:47]
    v_mfma_f32_32x32x16_bf16 v[48:63], v[64:67], v[104:107], v[48:63]
    ds_read_b128 v[76:79], v14 offset:1376
    v_xor_b32 v19, 32, v15
    ds_read_b128 v[100:103], v19 offset:35328
    s_waitcnt lgkmcnt(4)
    v_mfma_f32_32x32x16_bf16 v[32:47], v[92:95], v[108:111], v[32:47]
    v_mfma_f32_32x32x16_bf16 v[48:63], v[68:71], v[108:111], v[48:63]
    ds_read_b128 v[80:83], v14 offset:1408
    v_xor_b32 v20, 64, v15
    ds_read_b128 v[104:107], v20 offset:35328
    s_waitcnt lgkmcnt(4)
    v_mfma_f32_32x32x16_bf16 v[32:47], v[64:67], v[96:99], v[32:47]
    v_mfma_f32_32x32x16_bf16 v[48:63], v[72:75], v[96:99], v[48:63]
    ds_read_b128 v[84:87], v14 offset:1440
    v_xor_b32 v21, 96, v15
    ds_read_b128 v[108:111], v21 offset:35328
    s_waitcnt lgkmcnt(4)
    v_mfma_f32_32x32x16_bf16 v[32:47], v[68:71], v[100:103], v[32:47]
    v_mfma_f32_32x32x16_bf16 v[48:63], v[76:79], v[100:103], v[48:63]
    ds_read_b128 v[88:91], v14 offset:1472
    v_add_u32 v17, 11, v16
    v_bfe_u32 v18, v17, 1, 3
    v_xor_b32 v18, v18, v7
    v_lshlrev_b32 v17, 7, v17
    v_lshl_add_u32 v15, v18, 4, v17
    ds_read_b128 v[96:99], v15 offset:35328
    s_waitcnt lgkmcnt(4)
    v_mfma_f32_32x32x16_bf16 v[32:47], v[72:75], v[104:107], v[32:47]
    v_mfma_f32_32x32x16_bf16 v[48:63], v[80:83], v[104:107], v[48:63]
    ds_read_b128 v[92:95], v14 offset:1504
    v_xor_b32 v19, 32, v15
    ds_read_b128 v[100:103], v19 offset:35328
    s_waitcnt lgkmcnt(4)
    v_mfma_f32_32x32x16_bf16 v[32:47], v[76:79], v[108:111], v[32:47]
    v_mfma_f32_32x32x16_bf16 v[48:63], v[84:87], v[108:111], v[48:63]
    ds_read_b128 v[64:67], v14 offset:1536
    v_xor_b32 v20, 64, v15
    ds_read_b128 v[104:107], v20 offset:35328
    s_waitcnt lgkmcnt(4)
    v_mfma_f32_32x32x16_bf16 v[32:47], v[80:83], v[96:99], v[32:47]
    v_mfma_f32_32x32x16_bf16 v[48:63], v[88:91], v[96:99], v[48:63]
    ds_read_b128 v[68:71], v14 offset:1568
    v_xor_b32 v21, 96, v15
    ds_read_b128 v[108:111], v21 offset:35328
    s_waitcnt lgkmcnt(4)
    v_mfma_f32_32x32x16_bf16 v[32:47], v[84:87], v[100:103], v[32:47]
    v_mfma_f32_32x32x16_bf16 v[48:63], v[92:95], v[100:103], v[48:63]
    ds_read_b128 v[72:75], v14 offset:1600
    v_add_u32 v17, 12, v16
    v_bfe_u32 v18, v17, 1, 3
    v_xor_b32 v18, v18, v7
    v_lshlrev_b32 v17, 7, v17
    v_lshl_add_u32 v15, v18, 4, v17
    ds_read_b128 v[96:99], v15 offset:35328
    s_waitcnt lgkmcnt(4)
    v_mfma_f32_32x32x16_bf16 v[32:47], v[88:91], v[104:107], v[32:47]
    v_mfma_f32_32x32x16_bf16 v[48:63], v[64:67], v[104:107], v[48:63]
    ds_read_b128 v[76:79], v14 offset:1632
    v_xor_b32 v19, 32, v15
    ds_read_b128 v[100:103], v19 offset:35328
    s_waitcnt lgkmcnt(4)
    v_mfma_f32_32x32x16_bf16 v[32:47], v[92:95], v[108:111], v[32:47]
    v_mfma_f32_32x32x16_bf16 v[48:63], v[68:71], v[108:111], v[48:63]
    ds_read_b128 v[80:83], v14 offset:1664
    v_xor_b32 v20, 64, v15
    ds_read_b128 v[104:107], v20 offset:35328
    s_waitcnt lgkmcnt(4)
    v_mfma_f32_32x32x16_bf16 v[32:47], v[64:67], v[96:99], v[32:47]
    v_mfma_f32_32x32x16_bf16 v[48:63], v[72:75], v[96:99], v[48:63]
    ds_read_b128 v[84:87], v14 offset:1696
    v_xor_b32 v21, 96, v15
    ds_read_b128 v[108:111], v21 offset:35328
    s_waitcnt lgkmcnt(4)
    v_mfma_f32_32x32x16_bf16 v[32:47], v[68:71], v[100:103], v[32:47]
    v_mfma_f32_32x32x16_bf16 v[48:63], v[76:79], v[100:103], v[48:63]
    ds_read_b128 v[88:91], v14 offset:1728
    v_add_u32 v17, 13, v16
    v_bfe_u32 v18, v17, 1, 3
    v_xor_b32 v18, v18, v7
    v_lshlrev_b32 v17, 7, v17
    v_lshl_add_u32 v15, v18, 4, v17
    ds_read_b128 v[96:99], v15 offset:35328
    s_waitcnt lgkmcnt(4)
    v_mfma_f32_32x32x16_bf16 v[32:47], v[72:75], v[104:107], v[32:47]
    v_mfma_f32_32x32x16_bf16 v[48:63], v[80:83], v[104:107], v[48:63]
    ds_read_b128 v[92:95], v14 offset:1760
    v_xor_b32 v19, 32, v15
    ds_read_b128 v[100:103], v19 offset:35328
    s_waitcnt lgkmcnt(4)
    v_mfma_f32_32x32x16_bf16 v[32:47], v[76:79], v[108:111], v[32:47]
    v_mfma_f32_32x32x16_bf16 v[48:63], v[84:87], v[108:111], v[48:63]
    ds_read_b128 v[64:67], v14 offset:1792
    v_xor_b32 v20, 64, v15
    ds_read_b128 v[104:107], v20 offset:35328
    s_waitcnt lgkmcnt(4)
    v_mfma_f32_32x32x16_bf16 v[32:47], v[80:83], v[96:99], v[32:47]
    v_mfma_f32_32x32x16_bf16 v[48:63], v[88:91], v[96:99], v[48:63]
    ds_read_b128 v[68:71], v14 offset:1824
    v_xor_b32 v21, 96, v15
    ds_read_b128 v[108:111], v21 offset:35328
    s_waitcnt lgkmcnt(4)
    v_mfma_f32_32x32x16_bf16 v[32:47], v[84:87], v[100:103], v[32:47]
    v_mfma_f32_32x32x16_bf16 v[48:63], v[92:95], v[100:103], v[48:63]
    ds_read_b128 v[72:75], v14 offset:1856
    v_add_u32 v17, 14, v16
    v_bfe_u32 v18, v17, 1, 3
    v_xor_b32 v18, v18, v7
    v_lshlrev_b32 v17, 7, v17
    v_lshl_add_u32 v15, v18, 4, v17
    ds_read_b128 v[96:99], v15 offset:35328
    s_waitcnt lgkmcnt(4)
    v_mfma_f32_32x32x16_bf16 v[32:47], v[88:91], v[104:107], v[32:47]
    v_mfma_f32_32x32x16_bf16 v[48:63], v[64:67], v[104:107], v[48:63]
    ds_read_b128 v[76:79], v14 offset:1888
    v_xor_b32 v19, 32, v15
    ds_read_b128 v[100:103], v19 offset:35328
    s_waitcnt lgkmcnt(4)
    v_mfma_f32_32x32x16_bf16 v[32:47], v[92:95], v[108:111], v[32:47]
    v_mfma_f32_32x32x16_bf16 v[48:63], v[68:71], v[108:111], v[48:63]
    ds_read_b128 v[80:83], v14 offset:1920
    v_xor_b32 v20, 64, v15
    ds_read_b128 v[104:107], v20 offset:35328
    s_waitcnt lgkmcnt(4)
    v_mfma_f32_32x32x16_bf16 v[32:47], v[64:67], v[96:99], v[32:47]
    v_mfma_f32_32x32x16_bf16 v[48:63], v[72:75], v[96:99], v[48:63]
    ds_read_b128 v[84:87], v14 offset:1952
    v_xor_b32 v21, 96, v15
    ds_read_b128 v[108:111], v21 offset:35328
    s_waitcnt lgkmcnt(4)
    v_mfma_f32_32x32x16_bf16 v[32:47], v[68:71], v[100:103], v[32:47]
    v_mfma_f32_32x32x16_bf16 v[48:63], v[76:79], v[100:103], v[48:63]
    ds_read_b128 v[88:91], v14 offset:1984
    v_add_u32 v17, 15, v16
    v_bfe_u32 v18, v17, 1, 3
    v_xor_b32 v18, v18, v7
    v_lshlrev_b32 v17, 7, v17
    v_lshl_add_u32 v15, v18, 4, v17
    ds_read_b128 v[96:99], v15 offset:35328
    s_waitcnt lgkmcnt(4)
    v_mfma_f32_32x32x16_bf16 v[32:47], v[72:75], v[104:107], v[32:47]
    v_mfma_f32_32x32x16_bf16 v[48:63], v[80:83], v[104:107], v[48:63]
    ds_read_b128 v[92:95], v14 offset:2016
    v_xor_b32 v19, 32, v15
    ds_read_b128 v[100:103], v19 offset:35328
    s_waitcnt lgkmcnt(4)
    v_mfma_f32_32x32x16_bf16 v[32:47], v[76:79], v[108:111], v[32:47]
    v_mfma_f32_32x32x16_bf16 v[48:63], v[84:87], v[108:111], v[48:63]
    ds_read_b128 v[64:67], v14 offset:2048
    v_xor_b32 v20, 64, v15
    ds_read_b128 v[104:107], v20 offset:35328
    s_waitcnt lgkmcnt(4)
    v_mfma_f32_32x32x16_bf16 v[32:47], v[80:83], v[96:99], v[32:47]
    v_mfma_f32_32x32x16_bf16 v[48:63], v[88:91], v[96:99], v[48:63]
    ds_read_b128 v[68:71], v14 offset:2080
    v_xor_b32 v21, 96, v15
    ds_read_b128 v[108:111], v21 offset:35328
    s_waitcnt lgkmcnt(4)
    v_mfma_f32_32x32x16_bf16 v[32:47], v[84:87], v[100:103], v[32:47]
    v_mfma_f32_32x32x16_bf16 v[48:63], v[92:95], v[100:103], v[48:63]
    ds_read_b128 v[72:75], v14 offset:2112
    v_add_u32 v17, 16, v16
    v_bfe_u32 v18, v17, 1, 3
    v_xor_b32 v18, v18, v7
    v_lshlrev_b32 v17, 7, v17
    v_lshl_add_u32 v15, v18, 4, v17
    ds_read_b128 v[96:99], v15 offset:35328
    s_waitcnt lgkmcnt(4)
    v_mfma_f32_32x32x16_bf16 v[32:47], v[88:91], v[104:107], v[32:47]
    v_mfma_f32_32x32x16_bf16 v[48:63], v[64:67], v[104:107], v[48:63]
    ds_read_b128 v[76:79], v14 offset:2144
    v_xor_b32 v19, 32, v15
    ds_read_b128 v[100:103], v19 offset:35328
    s_waitcnt lgkmcnt(4)
    v_mfma_f32_32x32x16_bf16 v[32:47], v[92:95], v[108:111], v[32:47]
    v_mfma_f32_32x32x16_bf16 v[48:63], v[68:71], v[108:111], v[48:63]
    s_waitcnt lgkmcnt(2)
    v_mfma_f32_32x32x16_bf16 v[32:47], v[64:67], v[96:99], v[32:47]
    v_mfma_f32_32x32x16_bf16 v[48:63], v[72:75], v[96:99], v[48:63]
    s_waitcnt lgkmcnt(0)
    v_mfma_f32_32x32x16_bf16 v[32:47], v[68:71], v[100:103], v[32:47]
    v_mfma_f32_32x32x16_bf16 v[48:63], v[76:79], v[100:103], v[48:63]
    s_branch K2_RED
K2_W2:
    s_cmp_eq_u32 s3, 2
    s_cbranch_scc0 K2_W3
    ds_read_b128 v[72:75], v14 offset:2112
    ds_read_b128 v[76:79], v14 offset:2144
    ds_read_b128 v[80:83], v14 offset:2176
    v_add_u32 v17, 16, v16
    v_bfe_u32 v18, v17, 1, 3
    v_xor_b32 v18, v18, v7
    v_lshlrev_b32 v17, 7, v17
    v_lshl_add_u32 v15, v18, 4, v17
    v_xor_b32 v20, 64, v15
    ds_read_b128 v[104:107], v20 offset:35328
    ds_read_b128 v[84:87], v14 offset:2208
    v_xor_b32 v21, 96, v15
    ds_read_b128 v[108:111], v21 offset:35328
    ds_read_b128 v[88:91], v14 offset:2240
    v_add_u32 v17, 17, v16
    v_bfe_u32 v18, v17, 1, 3
    v_xor_b32 v18, v18, v7
    v_lshlrev_b32 v17, 7, v17
    v_lshl_add_u32 v15, v18, 4, v17
    ds_read_b128 v[96:99], v15 offset:35328
    s_waitcnt lgkmcnt(4)
    v_mfma_f32_32x32x16_bf16 v[32:47], v[72:75], v[104:107], 0
    v_mfma_f32_32x32x16_bf16 v[48:63], v[80:83], v[104:107], 0
    ds_read_b128 v[92:95], v14 offset:2272
    v_xor_b32 v19, 32, v15
    ds_read_b128 v[100:103], v19 offset:35328
    s_waitcnt lgkmcnt(4)
    v_mfma_f32_32x32x16_bf16 v[32:47], v[76:79], v[108:111], v[32:47]
    v_mfma_f32_32x32x16_bf16 v[48:63], v[84:87], v[108:111], v[48:63]
    ds_read_b128 v[64:67], v14 offset:2304
    v_xor_b32 v20, 64, v15
    ds_read_b128 v[104:107], v20 offset:35328
    s_waitcnt lgkmcnt(4)
    v_mfma_f32_32x32x16_bf16 v[32:47], v[80:83], v[96:99], v[32:47]
    v_mfma_f32_32x32x16_bf16 v[48:63], v[88:91], v[96:99], v[48:63]
    ds_read_b128 v[68:71], v14 offset:2336
    v_xor_b32 v21, 96, v15
    ds_read_b128 v[108:111], v21 offset:35328
    s_waitcnt lgkmcnt(4)
    v_mfma_f32_32x32x16_bf16 v[32:47], v[84:87], v[100:103], v[32:47]
    v_mfma_f32_32x32x16_bf16 v[48:63], v[92:95], v[100:103], v[48:63]
    ds_read_b128 v[72:75], v14 offset:2368
    v_add_u32 v17, 18, v16
    v_bfe_u32 v18, v17, 1, 3
    v_xor_b32 v18, v18, v7
    v_lshlrev_b32 v17, 7, v17
    v_lshl_add_u32 v15, v18, 4, v17
    ds_read_b128 v[96:99], v15 offset:35328
    s_waitcnt lgkmcnt(4)
    v_mfma_f32_32x32x16_bf16 v[32:47], v[88:91], v[104:107], v[32:47]
    v_mfma_f32_32x32x16_bf16 v[48:63], v[64:67], v[104:107], v[48:63]
    ds_read_b128 v[76:79], v14 offset:2400
    v_xor_b32 v19, 32, v15
    ds_read_b128 v[100:103], v19 offset:35328
    s_waitcnt lgkmcnt(4)
    v_mfma_f32_32x32x16_bf16 v[32:47], v[92:95], v[108:111], v[32:47]
    v_mfma_f32_32x32x16_bf16 v[48:63], v[68:71], v[108:111], v[48:63]
    ds_read_b128 v[80:83], v14 offset:2432
    v_xor_b32 v20, 64, v15
    ds_read_b128 v[104:107], v20 offset:35328
    s_waitcnt lgkmcnt(4)
    v_mfma_f32_32x32x16_bf16 v[32:47], v[64:67], v[96:99], v[32:47]
    v_mfma_f32_32x32x16_bf16 v[48:63], v[72:75], v[96:99], v[48:63]
    ds_read_b128 v[84:87], v14 offset:2464
    v_xor_b32 v21, 96, v15
    ds_read_b128 v[108:111], v21 offset:35328
    s_waitcnt lgkmcnt(4)
    v_mfma_f32_32x32x16_bf16 v[32:47], v[68:71], v[100:103], v[32:47]
    v_mfma_f32_32x32x16_bf16 v[48:63], v[76:79], v[100:103], v[48:63]
    ds_read_b128 v[88:91], v14 offset:2496
    v_add_u32 v17, 19, v16
    v_bfe_u32 v18, v17, 1, 3
    v_xor_b32 v18, v18, v7
    v_lshlrev_b32 v17, 7, v17
    v_lshl_add_u32 v15, v18, 4, v17
    ds_read_b128 v[96:99], v15 offset:35328
    s_waitcnt lgkmcnt(4)
    v_mfma_f32_32x32x16_bf16 v[32:47], v[72:75], v[104:107], v[32:47]
    v_mfma_f32_32x32x16_bf16 v[48:63], v[80:83], v[104:107], v[48:63]
    ds_read_b128 v[92:95], v14 offset:2528
    v_xor_b32 v19, 32, v15
    ds_read_b128 v[100:103], v19 offset:35328
    s_waitcnt lgkmcnt(4)
    v_mfma_f32_32x32x16_bf16 v[32:47], v[76:79], v[108:111], v[32:47]
    v_mfma_f32_32x32x16_bf16 v[48:63], v[84:87], v[108:111], v[48:63]
    ds_read_b128 v[64:67], v14 offset:2560
    v_xor_b32 v20, 64, v15
    ds_read_b128 v[104:107], v20 offset:35328
    s_waitcnt lgkmcnt(4)
    v_mfma_f32_32x32x16_bf16 v[32:47], v[80:83], v[96:99], v[32:47]
    v_mfma_f32_32x32x16_bf16 v[48:63], v[88:91], v[96:99], v[48:63]
    ds_read_b128 v[68:71], v14 offset:2592
    v_xor_b32 v21, 96, v15
    ds_read_b128 v[108:111], v21 offset:35328
    s_waitcnt lgkmcnt(4)
    v_mfma_f32_32x32x16_bf16 v[32:47], v[84:87], v[100:103], v[32:47]
    v_mfma_f32_32x32x16_bf16 v[48:63], v[92:95], v[100:103], v[48:63]
    ds_read_b128 v[72:75], v14 offset:2624
    v_add_u32 v17, 20, v16
    v_bfe_u32 v18, v17, 1, 3
    v_xor_b32 v18, v18, v7
    v_lshlrev_b32 v17, 7, v17
    v_lshl_add_u32 v15, v18, 4, v17
    ds_read_b128 v[96:99], v15 offset:35328
    s_waitcnt lgkmcnt(4)
    v_mfma_f32_32x32x16_bf16 v[32:47], v[88:91], v[104:107], v[32:47]
    v_mfma_f32_32x32x16_bf16 v[48:63], v[64:67], v[104:107], v[48:63]
    ds_read_b128 v[76:79], v14 offset:2656
    v_xor_b32 v19, 32, v15
    ds_read_b128 v[100:103], v19 offset:35328
    s_waitcnt lgkmcnt(4)
    v_mfma_f32_32x32x16_bf16 v[32:47], v[92:95], v[108:111], v[32:47]
    v_mfma_f32_32x32x16_bf16 v[48:63], v[68:71], v[108:111], v[48:63]
    ds_read_b128 v[80:83], v14 offset:2688
    v_xor_b32 v20, 64, v15
    ds_read_b128 v[104:107], v20 offset:35328
    s_waitcnt lgkmcnt(4)
    v_mfma_f32_32x32x16_bf16 v[32:47], v[64:67], v[96:99], v[32:47]
    v_mfma_f32_32x32x16_bf16 v[48:63], v[72:75], v[96:99], v[48:63]
    ds_read_b128 v[84:87], v14 offset:2720
    v_xor_b32 v21, 96, v15
    ds_read_b128 v[108:111], v21 offset:35328
    s_waitcnt lgkmcnt(4)
    v_mfma_f32_32x32x16_bf16 v[32:47], v[68:71], v[100:103], v[32:47]
    v_mfma_f32_32x32x16_bf16 v[48:63], v[76:79], v[100:103], v[48:63]
    ds_read_b128 v[88:91], v14 offset:2752
    v_add_u32 v17, 21, v16
    v_bfe_u32 v18, v17, 1, 3
    v_xor_b32 v18, v18, v7
    v_lshlrev_b32 v17, 7, v17
    v_lshl_add_u32 v15, v18, 4, v17
    ds_read_b128 v[96:99], v15 offset:35328
    s_waitcnt lgkmcnt(4)
    v_mfma_f32_32x32x16_bf16 v[32:47], v[72:75], v[104:107], v[32:47]
    v_mfma_f32_32x32x16_bf16 v[48:63], v[80:83], v[104:107], v[48:63]
    ds_read_b128 v[92:95], v14 offset:2784
    v_xor_b32 v19, 32, v15
    ds_read_b128 v[100:103], v19 offset:35328
    s_waitcnt lgkmcnt(4)
    v_mfma_f32_32x32x16_bf16 v[32:47], v[76:79], v[108:111], v[32:47]
    v_mfma_f32_32x32x16_bf16 v[48:63], v[84:87], v[108:111], v[48:63]
    ds_read_b128 v[64:67], v14 offset:2816
    v_xor_b32 v20, 64, v15
    ds_read_b128 v[104:107], v20 offset:35328
    s_waitcnt lgkmcnt(4)
    v_mfma_f32_32x32x16_bf16 v[32:47], v[80:83], v[96:99], v[32:47]
    v_mfma_f32_32x32x16_bf16 v[48:63], v[88:91], v[96:99], v[48:63]
    ds_read_b128 v[68:71], v14 offset:2848
    v_xor_b32 v21, 96, v15
    ds_read_b128 v[108:111], v21 offset:35328
    s_waitcnt lgkmcnt(4)
    v_mfma_f32_32x32x16_bf16 v[32:47], v[84:87], v[100:103], v[32:47]
    v_mfma_f32_32x32x16_bf16 v[48:63], v[92:95], v[100:103], v[48:63]
    ds_read_b128 v[72:75], v14 offset:2880
    v_add_u32 v17, 22, v16
    v_bfe_u32 v18, v17, 1, 3
    v_xor_b32 v18, v18, v7
    v_lshlrev_b32 v17, 7, v17
    v_lshl_add_u32 v15, v18, 4, v17
    ds_read_b128 v[96:99], v15 offset:35328
    s_waitcnt lgkmcnt(4)
    v_mfma_f32_32x32x16_bf16 v[32:47], v[88:91], v[104:107], v[32:47]
    v_mfma_f32_32x32x16_bf16 v[48:63], v[64:67], v[104:107], v[48:63]
    ds_read_b128 v[76:79], v14 offset:2912
    v_xor_b32 v19, 32, v15
    ds_read_b128 v[100:103], v19 offset:35328
    s_waitcnt lgkmcnt(4)
    v_mfma_f32_32x32x16_bf16 v[32:47], v[92:95], v[108:111], v[32:47]
    v_mfma_f32_32x32x16_bf16 v[48:63], v[68:71], v[108:111], v[48:63]
    ds_read_b128 v[80:83], v14 offset:2944
    v_xor_b32 v20, 64, v15
    ds_read_b128 v[104:107], v20 offset:35328
    s_waitcnt lgkmcnt(4)
    v_mfma_f32_32x32x16_bf16 v[32:47], v[64:67], v[96:99], v[32:47]
    v_mfma_f32_32x32x16_bf16 v[48:63], v[72:75], v[96:99], v[48:63]
    ds_read_b128 v[84:87], v14 offset:2976
    v_xor_b32 v21, 96, v15
    ds_read_b128 v[108:111], v21 offset:35328
    s_waitcnt lgkmcnt(4)
    v_mfma_f32_32x32x16_bf16 v[32:47], v[68:71], v[100:103], v[32:47]
    v_mfma_f32_32x32x16_bf16 v[48:63], v[76:79], v[100:103], v[48:63]
    ds_read_b128 v[88:91], v14 offset:3008
    v_add_u32 v17, 23, v16
    v_bfe_u32 v18, v17, 1, 3
    v_xor_b32 v18, v18, v7
    v_lshlrev_b32 v17, 7, v17
    v_lshl_add_u32 v15, v18, 4, v17
    ds_read_b128 v[96:99], v15 offset:35328
    s_waitcnt lgkmcnt(4)
    v_mfma_f32_32x32x16_bf16 v[32:47], v[72:75], v[104:107], v[32:47]
    v_mfma_f32_32x32x16_bf16 v[48:63], v[80:83], v[104:107], v[48:63]
    ds_read_b128 v[92:95], v14 offset:3040
    v_xor_b32 v19, 32, v15
    ds_read_b128 v[100:103], v19 offset:35328
    s_waitcnt lgkmcnt(4)
    v_mfma_f32_32x32x16_bf16 v[32:47], v[76:79], v[108:111], v[32:47]
    v_mfma_f32_32x32x16_bf16 v[48:63], v[84:87], v[108:111], v[48:63]
    ds_read_b128 v[64:67], v14 offset:3072
    v_xor_b32 v20, 64, v15
    ds_read_b128 v[104:107], v20 offset:35328
    s_waitcnt lgkmcnt(4)
    v_mfma_f32_32x32x16_bf16 v[32:47], v[80:83], v[96:99], v[32:47]
    v_mfma_f32_32x32x16_bf16 v[48:63], v[88:91], v[96:99], v[48:63]
    ds_read_b128 v[68:71], v14 offset:3104
    v_xor_b32 v21, 96, v15
    ds_read_b128 v[108:111], v21 offset:35328
    s_waitcnt lgkmcnt(4)
    v_mfma_f32_32x32x16_bf16 v[32:47], v[84:87], v[100:103], v[32:47]
    v_mfma_f32_32x32x16_bf16 v[48:63], v[92:95], v[100:103], v[48:63]
    ds_read_b128 v[72:75], v14 offset:3136
    v_add_u32 v17, 24, v16
    v_bfe_u32 v18, v17, 1, 3
    v_xor_b32 v18, v18, v7
    v_lshlrev_b32 v17, 7, v17
    v_lshl_add_u32 v15, v18, 4, v17
    ds_read_b128 v[96:99], v15 offset:35328
    s_waitcnt lgkmcnt(4)
    v_mfma_f32_32x32x16_bf16 v[32:47], v[88:91], v[104:107], v[32:47]
    v_mfma_f32_32x32x16_bf16 v[48:63], v[64:67], v[104:107], v[48:63]
    ds_read_b128 v[76:79], v14 offset:3168
    v_xor_b32 v19, 32, v15
    ds_read_b128 v[100:103], v19 offset:35328
    s_waitcnt lgkmcnt(4)
    v_mfma_f32_32x32x16_bf16 v[32:47], v[92:95], v[108:111], v[32:47]
    v_mfma_f32_32x32x16_bf16 v[48:63], v[68:71], v[108:111], v[48:63]
    ds_read_b128 v[80:83], v14 offset:3200
    v_xor_b32 v20, 64, v15
    ds_read_b128 v[104:107], v20 offset:35328
    s_waitcnt lgkmcnt(4)
    v_mfma_f32_32x32x16_bf16 v[32:47], v[64:67], v[96:99], v[32:47]
    v_mfma_f32_32x32x16_bf16 v[48:63], v[72:75], v[96:99], v[48:63]
    s_waitcnt lgkmcnt(2)
    v_mfma_f32_32x32x16_bf16 v[32:47], v[68:71], v[100:103], v[32:47]
    v_mfma_f32_32x32x16_bf16 v[48:63], v[76:79], v[100:103], v[48:63]
    s_waitcnt lgkmcnt(0)
    v_mfma_f32_32x32x16_bf16 v[32:47], v[72:75], v[104:107], v[32:47]
    v_mfma_f32_32x32x16_bf16 v[48:63], v[80:83], v[104:107], v[48:63]
    s_branch K2_RED
K2_W3:
    ds_read_b128 v[76:79], v14 offset:3168
    ds_read_b128 v[80:83], v14 offset:3200
    ds_read_b128 v[84:87], v14 offset:3232
    v_add_u32 v17, 24, v16
    v_bfe_u32 v18, v17, 1, 3
    v_xor_b32 v18, v18, v7
    v_lshlrev_b32 v17, 7, v17
    v_lshl_add_u32 v15, v18, 4, v17
    v_xor_b32 v21, 96, v15
    ds_read_b128 v[108:111], v21 offset:35328
    ds_read_b128 v[88:91], v14 offset:3264
    v_add_u32 v17, 25, v16
    v_bfe_u32 v18, v17, 1, 3
    v_xor_b32 v18, v18, v7
    v_lshlrev_b32 v17, 7, v17
    v_lshl_add_u32 v15, v18, 4, v17
    ds_read_b128 v[96:99], v15 offset:35328
    ds_read_b128 v[92:95], v14 offset:3296
    v_xor_b32 v19, 32, v15
    ds_read_b128 v[100:103], v19 offset:35328
    s_waitcnt lgkmcnt(4)
    v_mfma_f32_32x32x16_bf16 v[32:47], v[76:79], v[108:111], 0
    v_mfma_f32_32x32x16_bf16 v[48:63], v[84:87], v[108:111], 0
    ds_read_b128 v[64:67], v14 offset:3328
    v_xor_b32 v20, 64, v15
    ds_read_b128 v[104:107], v20 offset:35328
    s_waitcnt lgkmcnt(4)
    v_mfma_f32_32x32x16_bf16 v[32:47], v[80:83], v[96:99], v[32:47]
    v_mfma_f32_32x32x16_bf16 v[48:63], v[88:91], v[96:99], v[48:63]
    ds_read_b128 v[68:71], v14 offset:3360
    v_xor_b32 v21, 96, v15
    ds_read_b128 v[108:111], v21 offset:35328
    s_waitcnt lgkmcnt(4)
    v_mfma_f32_32x32x16_bf16 v[32:47], v[84:87], v[100:103], v[32:47]
    v_mfma_f32_32x32x16_bf16 v[48:63], v[92:95], v[100:103], v[48:63]
    ds_read_b128 v[72:75], v14 offset:3392
    v_add_u32 v17, 26, v16
    v_bfe_u32 v18, v17, 1, 3
    v_xor_b32 v18, v18, v7
    v_lshlrev_b32 v17, 7, v17
    v_lshl_add_u32 v15, v18, 4, v17
    ds_read_b128 v[96:99], v15 offset:35328
    s_waitcnt lgkmcnt(4)
    v_mfma_f32_32x32x16_bf16 v[32:47], v[88:91], v[104:107], v[32:47]
    v_mfma_f32_32x32x16_bf16 v[48:63], v[64:67], v[104:107], v[48:63]
    ds_read_b128 v[76:79], v14 offset:3424
    v_xor_b32 v19, 32, v15
    ds_read_b128 v[100:103], v19 offset:35328
    s_waitcnt lgkmcnt(4)
    v_mfma_f32_32x32x16_bf16 v[32:47], v[92:95], v[108:111], v[32:47]
    v_mfma_f32_32x32x16_bf16 v[48:63], v[68:71], v[108:111], v[48:63]
    ds_read_b128 v[80:83], v14 offset:3456
    v_xor_b32 v20, 64, v15
    ds_read_b128 v[104:107], v20 offset:35328
    s_waitcnt lgkmcnt(4)
    v_mfma_f32_32x32x16_bf16 v[32:47], v[64:67], v[96:99], v[32:47]
    v_mfma_f32_32x32x16_bf16 v[48:63], v[72:75], v[96:99], v[48:63]
    ds_read_b128 v[84:87], v14 offset:3488
    v_xor_b32 v21, 96, v15
    ds_read_b128 v[108:111], v21 offset:35328
    s_waitcnt lgkmcnt(4)
    v_mfma_f32_32x32x16_bf16 v[32:47], v[68:71], v[100:103], v[32:47]
    v_mfma_f32_32x32x16_bf16 v[48:63], v[76:79], v[100:103], v[48:63]
    ds_read_b128 v[88:91], v14 offset:3520
    v_add_u32 v17, 27, v16
    v_bfe_u32 v18, v17, 1, 3
    v_xor_b32 v18, v18, v7
    v_lshlrev_b32 v17, 7, v17
    v_lshl_add_u32 v15, v18, 4, v17
    ds_read_b128 v[96:99], v15 offset:35328
    s_waitcnt lgkmcnt(4)
    v_mfma_f32_32x32x16_bf16 v[32:47], v[72:75], v[104:107], v[32:47]
    v_mfma_f32_32x32x16_bf16 v[48:63], v[80:83], v[104:107], v[48:63]
    ds_read_b128 v[92:95], v14 offset:3552
    v_xor_b32 v19, 32, v15
    ds_read_b128 v[100:103], v19 offset:35328
    s_waitcnt lgkmcnt(4)
    v_mfma_f32_32x32x16_bf16 v[32:47], v[76:79], v[108:111], v[32:47]
    v_mfma_f32_32x32x16_bf16 v[48:63], v[84:87], v[108:111], v[48:63]
    ds_read_b128 v[64:67], v14 offset:3584
    v_xor_b32 v20, 64, v15
    ds_read_b128 v[104:107], v20 offset:35328
    s_waitcnt lgkmcnt(4)
    v_mfma_f32_32x32x16_bf16 v[32:47], v[80:83], v[96:99], v[32:47]
    v_mfma_f32_32x32x16_bf16 v[48:63], v[88:91], v[96:99], v[48:63]
    ds_read_b128 v[68:71], v14 offset:3616
    v_xor_b32 v21, 96, v15
    ds_read_b128 v[108:111], v21 offset:35328
    s_waitcnt lgkmcnt(4)
    v_mfma_f32_32x32x16_bf16 v[32:47], v[84:87], v[100:103], v[32:47]
    v_mfma_f32_32x32x16_bf16 v[48:63], v[92:95], v[100:103], v[48:63]
    ds_read_b128 v[72:75], v14 offset:3648
    v_add_u32 v17, 28, v16
    v_bfe_u32 v18, v17, 1, 3
    v_xor_b32 v18, v18, v7
    v_lshlrev_b32 v17, 7, v17
    v_lshl_add_u32 v15, v18, 4, v17
    ds_read_b128 v[96:99], v15 offset:35328
    s_waitcnt lgkmcnt(4)
    v_mfma_f32_32x32x16_bf16 v[32:47], v[88:91], v[104:107], v[32:47]
    v_mfma_f32_32x32x16_bf16 v[48:63], v[64:67], v[104:107], v[48:63]
    ds_read_b128 v[76:79], v14 offset:3680
    v_xor_b32 v19, 32, v15
    ds_read_b128 v[100:103], v19 offset:35328
    s_waitcnt lgkmcnt(4)
    v_mfma_f32_32x32x16_bf16 v[32:47], v[92:95], v[108:111], v[32:47]
    v_mfma_f32_32x32x16_bf16 v[48:63], v[68:71], v[108:111], v[48:63]
    ds_read_b128 v[80:83], v14 offset:3712
    v_xor_b32 v20, 64, v15
    ds_read_b128 v[104:107], v20 offset:35328
    s_waitcnt lgkmcnt(4)
    v_mfma_f32_32x32x16_bf16 v[32:47], v[64:67], v[96:99], v[32:47]
    v_mfma_f32_32x32x16_bf16 v[48:63], v[72:75], v[96:99], v[48:63]
    ds_read_b128 v[84:87], v14 offset:3744
    v_xor_b32 v21, 96, v15
    ds_read_b128 v[108:111], v21 offset:35328
    s_waitcnt lgkmcnt(4)
    v_mfma_f32_32x32x16_bf16 v[32:47], v[68:71], v[100:103], v[32:47]
    v_mfma_f32_32x32x16_bf16 v[48:63], v[76:79], v[100:103], v[48:63]
    ds_read_b128 v[88:91], v14 offset:3776
    v_add_u32 v17, 29, v16
    v_bfe_u32 v18, v17, 1, 3
    v_xor_b32 v18, v18, v7
    v_lshlrev_b32 v17, 7, v17
    v_lshl_add_u32 v15, v18, 4, v17
    ds_read_b128 v[96:99], v15 offset:35328
    s_waitcnt lgkmcnt(4)
    v_mfma_f32_32x32x16_bf16 v[32:47], v[72:75], v[104:107], v[32:47]
    v_mfma_f32_32x32x16_bf16 v[48:63], v[80:83], v[104:107], v[48:63]
    ds_read_b128 v[92:95], v14 offset:3808
    v_xor_b32 v19, 32, v15
    ds_read_b128 v[100:103], v19 offset:35328
    s_waitcnt lgkmcnt(4)
    v_mfma_f32_32x32x16_bf16 v[32:47], v[76:79], v[108:111], v[32:47]
    v_mfma_f32_32x32x16_bf16 v[48:63], v[84:87], v[108:111], v[48:63]
    ds_read_b128 v[64:67], v14 offset:3840
    v_xor_b32 v20, 64, v15
    ds_read_b128 v[104:107], v20 offset:35328
    s_waitcnt lgkmcnt(4)
    v_mfma_f32_32x32x16_bf16 v[32:47], v[80:83], v[96:99], v[32:47]
    v_mfma_f32_32x32x16_bf16 v[48:63], v[88:91], v[96:99], v[48:63]
    ds_read_b128 v[68:71], v14 offset:3872
    v_xor_b32 v21, 96, v15
    ds_read_b128 v[108:111], v21 offset:35328
    s_waitcnt lgkmcnt(4)
    v_mfma_f32_32x32x16_bf16 v[32:47], v[84:87], v[100:103], v[32:47]
    v_mfma_f32_32x32x16_bf16 v[48:63], v[92:95], v[100:103], v[48:63]
    ds_read_b128 v[72:75], v14 offset:3904
    v_add_u32 v17, 30, v16
    v_bfe_u32 v18, v17, 1, 3
    v_xor_b32 v18, v18, v7
    v_lshlrev_b32 v17, 7, v17
    v_lshl_add_u32 v15, v18, 4, v17
    ds_read_b128 v[96:99], v15 offset:35328
    s_waitcnt lgkmcnt(4)
    v_mfma_f32_32x32x16_bf16 v[32:47], v[88:91], v[104:107], v[32:47]
    v_mfma_f32_32x32x16_bf16 v[48:63], v[64:67], v[104:107], v[48:63]
    ds_read_b128 v[76:79], v14 offset:3936
    v_xor_b32 v19, 32, v15
    ds_read_b128 v[100:103], v19 offset:35328
    s_waitcnt lgkmcnt(4)
    v_mfma_f32_32x32x16_bf16 v[32:47], v[92:95], v[108:111], v[32:47]
    v_mfma_f32_32x32x16_bf16 v[48:63], v[68:71], v[108:111], v[48:63]
    ds_read_b128 v[80:83], v14 offset:3968
    v_xor_b32 v20, 64, v15
    ds_read_b128 v[104:107], v20 offset:35328
    s_waitcnt lgkmcnt(4)
    v_mfma_f32_32x32x16_bf16 v[32:47], v[64:67], v[96:99], v[32:47]
    v_mfma_f32_32x32x16_bf16 v[48:63], v[72:75], v[96:99], v[48:63]
    ds_read_b128 v[84:87], v14 offset:4000
    v_xor_b32 v21, 96, v15
    ds_read_b128 v[108:111], v21 offset:35328
    s_waitcnt lgkmcnt(4)
    v_mfma_f32_32x32x16_bf16 v[32:47], v[68:71], v[100:103], v[32:47]
    v_mfma_f32_32x32x16_bf16 v[48:63], v[76:79], v[100:103], v[48:63]
    ds_read_b128 v[88:91], v14 offset:4032
    v_add_u32 v17, 31, v16
    v_bfe_u32 v18, v17, 1, 3
    v_xor_b32 v18, v18, v7
    v_lshlrev_b32 v17, 7, v17
    v_lshl_add_u32 v15, v18, 4, v17
    ds_read_b128 v[96:99], v15 offset:35328
    s_waitcnt lgkmcnt(4)
    v_mfma_f32_32x32x16_bf16 v[32:47], v[72:75], v[104:107], v[32:47]
    v_mfma_f32_32x32x16_bf16 v[48:63], v[80:83], v[104:107], v[48:63]
    ds_read_b128 v[92:95], v14 offset:4064
    v_xor_b32 v19, 32, v15
    ds_read_b128 v[100:103], v19 offset:35328
    s_waitcnt lgkmcnt(4)
    v_mfma_f32_32x32x16_bf16 v[32:47], v[76:79], v[108:111], v[32:47]
    v_mfma_f32_32x32x16_bf16 v[48:63], v[84:87], v[108:111], v[48:63]
    ds_read_b128 v[64:67], v14 offset:4096
    v_xor_b32 v20, 64, v15
    ds_read_b128 v[104:107], v20 offset:35328
    s_waitcnt lgkmcnt(4)
    v_mfma_f32_32x32x16_bf16 v[32:47], v[80:83], v[96:99], v[32:47]
    v_mfma_f32_32x32x16_bf16 v[48:63], v[88:91], v[96:99], v[48:63]
    ds_read_b128 v[68:71], v14 offset:4128
    v_xor_b32 v21, 96, v15
    ds_read_b128 v[108:111], v21 offset:35328
    s_waitcnt lgkmcnt(4)
    v_mfma_f32_32x32x16_bf16 v[32:47], v[84:87], v[100:103], v[32:47]
    v_mfma_f32_32x32x16_bf16 v[48:63], v[92:95], v[100:103], v[48:63]
    ds_read_b128 v[72:75], v14 offset:4160
    v_add_u32 v17, 32, v16
    v_bfe_u32 v18, v17, 1, 3
    v_xor_b32 v18, v18, v7
    v_lshlrev_b32 v17, 7, v17
    v_lshl_add_u32 v15, v18, 4, v17
    ds_read_b128 v[96:99], v15 offset:35328
    s_waitcnt lgkmcnt(4)
    v_mfma_f32_32x32x16_bf16 v[32:47], v[88:91], v[104:107], v[32:47]
    v_mfma_f32_32x32x16_bf16 v[48:63], v[64:67], v[104:107], v[48:63]
    ds_read_b128 v[76:79], v14 offset:4192
    v_xor_b32 v19, 32, v15
    ds_read_b128 v[100:103], v19 offset:35328
    s_waitcnt lgkmcnt(4)
    v_mfma_f32_32x32x16_bf16 v[32:47], v[92:95], v[108:111], v[32:47]
    v_mfma_f32_32x32x16_bf16 v[48:63], v[68:71], v[108:111], v[48:63]
    ds_read_b128 v[80:83], v14 offset:4224
    v_xor_b32 v20, 64, v15
    ds_read_b128 v[104:107], v20 offset:35328
    s_waitcnt lgkmcnt(4)
    v_mfma_f32_32x32x16_bf16 v[32:47], v[64:67], v[96:99], v[32:47]
    v_mfma_f32_32x32x16_bf16 v[48:63], v[72:75], v[96:99], v[48:63]
    ds_read_b128 v[84:87], v14 offset:4256
    v_xor_b32 v21, 96, v15
    ds_read_b128 v[108:111], v21 offset:35328
    s_waitcnt lgkmcnt(4)
    v_mfma_f32_32x32x16_bf16 v[32:47], v[68:71], v[100:103], v[32:47]
    v_mfma_f32_32x32x16_bf16 v[48:63], v[76:79], v[100:103], v[48:63]
    s_waitcnt lgkmcnt(2)
    v_mfma_f32_32x32x16_bf16 v[32:47], v[72:75], v[104:107], v[32:47]
    v_mfma_f32_32x32x16_bf16 v[48:63], v[80:83], v[104:107], v[48:63]
    s_waitcnt lgkmcnt(0)
    v_mfma_f32_32x32x16_bf16 v[32:47], v[76:79], v[108:111], v[32:47]
    v_mfma_f32_32x32x16_bf16 v[48:63], v[84:87], v[108:111], v[48:63]
K2_RED:
    v_lshrrev_b32 v21, 3, v0
    v_and_b32 v22, 7, v0
    v_mul_u32_u24 v21, 272, v21
    v_lshl_add_u32 v21, v22, 5, v21
    v_lshlrev_b32 v22, 3, v0
    v_sub_u32 v22, 2040, v22
    v_lshrrev_b32 v23, 6, v22
    v_bfe_u32 v22, v22, 3, 3
    v_bfe_u32 v24, v23, 1, 3
    v_xor_b32 v22, v22, v24
    v_lshlrev_b32 v22, 4, v22
    v_lshl_add_u32 v22, v23, 7, v22
    ds_read_b128 v[24:27], v22 offset:35328
    s_waitcnt lgkmcnt(0)
    v_and_b32 v102, 0xffff0000, v24
    v_lshlrev_b32 v103, 16, v24
    v_and_b32 v100, 0xffff0000, v25
    v_lshlrev_b32 v101, 16, v25
    v_and_b32 v98, 0xffff0000, v26
    v_lshlrev_b32 v99, 16, v26
    v_and_b32 v96, 0xffff0000, v27
    v_lshlrev_b32 v97, 16, v27
    v_lshlrev_b32 v104, 16, v8
    v_and_b32 v105, 0xffff0000, v8
    v_lshlrev_b32 v106, 16, v9
    v_and_b32 v107, 0xffff0000, v9
    v_lshlrev_b32 v108, 16, v10
    v_and_b32 v109, 0xffff0000, v10
    v_lshlrev_b32 v110, 16, v11
    v_and_b32 v111, 0xffff0000, v11
    v_lshlrev_b32 v12, 16, v12
    v_mul_f32 v96, v12, v96
    v_mul_f32 v97, v12, v97
    v_cvt_pk_bf16_f32 v28, v96, v97
    v_lshlrev_b32 v96, 16, v28
    v_and_b32 v97, 0xffff0000, v28
    v_mul_f32 v98, v12, v98
    v_mul_f32 v99, v12, v99
    v_cvt_pk_bf16_f32 v29, v98, v99
    v_lshlrev_b32 v98, 16, v29
    v_and_b32 v99, 0xffff0000, v29
    v_mul_f32 v100, v12, v100
    v_mul_f32 v101, v12, v101
    v_cvt_pk_bf16_f32 v30, v100, v101
    v_lshlrev_b32 v100, 16, v30
    v_and_b32 v101, 0xffff0000, v30
    v_mul_f32 v102, v12, v102
    v_mul_f32 v103, v12, v103
    v_cvt_pk_bf16_f32 v31, v102, v103
    v_lshlrev_b32 v102, 16, v31
    v_and_b32 v103, 0xffff0000, v31
    s_barrier
    v_mul_u32_u24 v20, 272, v6
    v_lshl_add_u32 v20, v7, 4, v20
    s_mul_i32 s34, s3, 8704
    v_add_u32 v20, s34, v20
    s_nop 11
    ds_write_b128 v20, v[32:35] offset:0
    ds_write_b128 v20, v[36:39] offset:32
    ds_write_b128 v20, v[40:43] offset:64
    ds_write_b128 v20, v[44:47] offset:96
    ds_write_b128 v20, v[48:51] offset:128
    ds_write_b128 v20, v[52:55] offset:160
    ds_write_b128 v20, v[56:59] offset:192
    ds_write_b128 v20, v[60:63] offset:224
    s_waitcnt lgkmcnt(0)
    s_barrier
    ds_read_b128 v[64:67], v21 offset:0
    ds_read_b128 v[68:71], v21 offset:16
    ds_read_b128 v[72:75], v21 offset:8704
    ds_read_b128 v[76:79], v21 offset:8720
    ds_read_b128 v[80:83], v21 offset:17408
    ds_read_b128 v[84:87], v21 offset:17424
    ds_read_b128 v[88:91], v21 offset:26112
    ds_read_b128 v[92:95], v21 offset:26128
    s_waitcnt lgkmcnt(0)
    v_pk_add_f32 v[64:65], v[64:65], v[72:73]
    v_pk_add_f32 v[80:81], v[80:81], v[88:89]
    v_pk_add_f32 v[64:65], v[64:65], v[80:81]
    v_cvt_pk_bf16_f32 v28, v64, v65
    v_lshlrev_b32 v64, 16, v28
    v_and_b32 v65, 0xffff0000, v28
    v_pk_add_f32 v[64:65], v[64:65], v[96:97]
    v_cvt_pk_bf16_f32 v28, v64, v65
    v_lshlrev_b32 v64, 16, v28
    v_and_b32 v65, 0xffff0000, v28
    v_pk_add_f32 v[64:65], v[64:65], v[104:105]
    v_cvt_pk_bf16_f32 v28, v64, v65
    v_pk_add_f32 v[66:67], v[66:67], v[74:75]
    v_pk_add_f32 v[82:83], v[82:83], v[90:91]
    v_pk_add_f32 v[66:67], v[66:67], v[82:83]
    v_cvt_pk_bf16_f32 v29, v66, v67
    v_lshlrev_b32 v66, 16, v29
    v_and_b32 v67, 0xffff0000, v29
    v_pk_add_f32 v[66:67], v[66:67], v[98:99]
    v_cvt_pk_bf16_f32 v29, v66, v67
    v_lshlrev_b32 v66, 16, v29
    v_and_b32 v67, 0xffff0000, v29
    v_pk_add_f32 v[66:67], v[66:67], v[106:107]
    v_cvt_pk_bf16_f32 v29, v66, v67
    v_pk_add_f32 v[68:69], v[68:69], v[76:77]
    v_pk_add_f32 v[84:85], v[84:85], v[92:93]
    v_pk_add_f32 v[68:69], v[68:69], v[84:85]
    v_cvt_pk_bf16_f32 v30, v68, v69
    v_lshlrev_b32 v68, 16, v30
    v_and_b32 v69, 0xffff0000, v30
    v_pk_add_f32 v[68:69], v[68:69], v[100:101]
    v_cvt_pk_bf16_f32 v30, v68, v69
    v_lshlrev_b32 v68, 16, v30
    v_and_b32 v69, 0xffff0000, v30
    v_pk_add_f32 v[68:69], v[68:69], v[108:109]
    v_cvt_pk_bf16_f32 v30, v68, v69
    v_pk_add_f32 v[70:71], v[70:71], v[78:79]
    v_pk_add_f32 v[86:87], v[86:87], v[94:95]
    v_pk_add_f32 v[70:71], v[70:71], v[86:87]
    v_cvt_pk_bf16_f32 v31, v70, v71
    v_lshlrev_b32 v70, 16, v31
    v_and_b32 v71, 0xffff0000, v31
    v_pk_add_f32 v[70:71], v[70:71], v[102:103]
    v_cvt_pk_bf16_f32 v31, v70, v71
    v_lshlrev_b32 v70, 16, v31
    v_and_b32 v71, 0xffff0000, v31
    v_pk_add_f32 v[70:71], v[70:71], v[110:111]
    v_cvt_pk_bf16_f32 v31, v70, v71
    buffer_store_dwordx4 v[28:31], v4, s[20:23], s32 offen sc1
    s_endpgm
K2_CS:
    s_load_dwordx4 s[8:11], s[0:1], 80
    s_sub_u32 s3, s2, 448
    v_and_b32 v1, 7, v0
    v_lshrrev_b32 v2, 3, v0
    s_mov_b32 s30, 50176
    v_mul_lo_u32 v3, v2, s30
    v_lshl_add_u32 v3, v1, 4, v3
    s_waitcnt lgkmcnt(0)
    s_cmp_ge_u32 s3, 28
    s_cselect_b32 s8, s10, s8
    s_cselect_b32 s9, s11, s9
    s_cselect_b32 s31, 28, 0
    s_sub_u32 s31, s3, s31
    s_lshl_b32 s31, s31, 7
    s_mov_b32 s12, s8
    s_mov_b32 s13, s9
    s_mov_b32 s14, 1605632
    s_mov_b32 s15, 0x00020000
    s_add_u32 s16, s6, 7913472
    s_addc_u32 s17, s7, 0
    s_mov_b32 s18, 14336
    s_mov_b32 s19, 0x00020000
    buffer_load_dwordx4 v[32:35], v3, s[12:15], s31 offen
    s_add_u32 s31, s31, 3584
    buffer_load_dwordx4 v[36:39], v3, s[12:15], s31 offen
    s_add_u32 s31, s31, 3584
    buffer_load_dwordx4 v[40:43], v3, s[12:15], s31 offen
    s_add_u32 s31, s31, 3584
    buffer_load_dwordx4 v[44:47], v3, s[12:15], s31 offen
    s_add_u32 s31, s31, 3584
    buffer_load_dwordx4 v[48:51], v3, s[12:15], s31 offen
    s_add_u32 s31, s31, 3584
    buffer_load_dwordx4 v[52:55], v3, s[12:15], s31 offen
    s_add_u32 s31, s31, 3584
    buffer_load_dwordx4 v[56:59], v3, s[12:15], s31 offen
    s_add_u32 s31, s31, 3584
    buffer_load_dwordx4 v[60:63], v3, s[12:15], s31 offen
    s_add_u32 s31, s31, 3584
    buffer_load_dwordx4 v[64:67], v3, s[12:15], s31 offen
    s_add_u32 s31, s31, 3584
    buffer_load_dwordx4 v[68:71], v3, s[12:15], s31 offen
    s_add_u32 s31, s31, 3584
    buffer_load_dwordx4 v[72:75], v3, s[12:15], s31 offen
    s_add_u32 s31, s31, 3584
    buffer_load_dwordx4 v[76:79], v3, s[12:15], s31 offen
    s_add_u32 s31, s31, 3584
    buffer_load_dwordx4 v[80:83], v3, s[12:15], s31 offen
    s_add_u32 s31, s31, 3584
    buffer_load_dwordx4 v[84:87], v3, s[12:15], s31 offen
    s_add_u32 s31, s31, 3584
    v_mov_b32 v8, 0
    v_mov_b32 v9, 0
    v_mov_b32 v10, 0
    v_mov_b32 v11, 0
    v_mov_b32 v12, 0
    v_mov_b32 v13, 0
    v_mov_b32 v14, 0
    v_mov_b32 v15, 0
    s_waitcnt vmcnt(13)
    v_lshlrev_b32 v16, 16, v32
    v_and_b32 v17, 0xffff0000, v32
    v_pk_add_f32 v[8:9], v[8:9], v[16:17]
    v_lshlrev_b32 v16, 16, v33
    v_and_b32 v17, 0xffff0000, v33
    v_pk_add_f32 v[10:11], v[10:11], v[16:17]
    v_lshlrev_b32 v16, 16, v34
    v_and_b32 v17, 0xffff0000, v34
    v_pk_add_f32 v[12:13], v[12:13], v[16:17]
    v_lshlrev_b32 v16, 16, v35
    v_and_b32 v17, 0xffff0000, v35
    v_pk_add_f32 v[14:15], v[14:15], v[16:17]
    s_waitcnt vmcnt(12)
    v_lshlrev_b32 v16, 16, v36
    v_and_b32 v17, 0xffff0000, v36
    v_pk_add_f32 v[8:9], v[8:9], v[16:17]
    v_lshlrev_b32 v16, 16, v37
    v_and_b32 v17, 0xffff0000, v37
    v_pk_add_f32 v[10:11], v[10:11], v[16:17]
    v_lshlrev_b32 v16, 16, v38
    v_and_b32 v17, 0xffff0000, v38
    v_pk_add_f32 v[12:13], v[12:13], v[16:17]
    v_lshlrev_b32 v16, 16, v39
    v_and_b32 v17, 0xffff0000, v39
    v_pk_add_f32 v[14:15], v[14:15], v[16:17]
    s_waitcnt vmcnt(11)
    v_lshlrev_b32 v16, 16, v40
    v_and_b32 v17, 0xffff0000, v40
    v_pk_add_f32 v[8:9], v[8:9], v[16:17]
    v_lshlrev_b32 v16, 16, v41
    v_and_b32 v17, 0xffff0000, v41
    v_pk_add_f32 v[10:11], v[10:11], v[16:17]
    v_lshlrev_b32 v16, 16, v42
    v_and_b32 v17, 0xffff0000, v42
    v_pk_add_f32 v[12:13], v[12:13], v[16:17]
    v_lshlrev_b32 v16, 16, v43
    v_and_b32 v17, 0xffff0000, v43
    v_pk_add_f32 v[14:15], v[14:15], v[16:17]
    s_waitcnt vmcnt(10)
    v_lshlrev_b32 v16, 16, v44
    v_and_b32 v17, 0xffff0000, v44
    v_pk_add_f32 v[8:9], v[8:9], v[16:17]
    v_lshlrev_b32 v16, 16, v45
    v_and_b32 v17, 0xffff0000, v45
    v_pk_add_f32 v[10:11], v[10:11], v[16:17]
    v_lshlrev_b32 v16, 16, v46
    v_and_b32 v17, 0xffff0000, v46
    v_pk_add_f32 v[12:13], v[12:13], v[16:17]
    v_lshlrev_b32 v16, 16, v47
    v_and_b32 v17, 0xffff0000, v47
    v_pk_add_f32 v[14:15], v[14:15], v[16:17]
    s_waitcnt vmcnt(9)
    v_lshlrev_b32 v16, 16, v48
    v_and_b32 v17, 0xffff0000, v48
    v_pk_add_f32 v[8:9], v[8:9], v[16:17]
    v_lshlrev_b32 v16, 16, v49
    v_and_b32 v17, 0xffff0000, v49
    v_pk_add_f32 v[10:11], v[10:11], v[16:17]
    v_lshlrev_b32 v16, 16, v50
    v_and_b32 v17, 0xffff0000, v50
    v_pk_add_f32 v[12:13], v[12:13], v[16:17]
    v_lshlrev_b32 v16, 16, v51
    v_and_b32 v17, 0xffff0000, v51
    v_pk_add_f32 v[14:15], v[14:15], v[16:17]
    s_waitcnt vmcnt(8)
    v_lshlrev_b32 v16, 16, v52
    v_and_b32 v17, 0xffff0000, v52
    v_pk_add_f32 v[8:9], v[8:9], v[16:17]
    v_lshlrev_b32 v16, 16, v53
    v_and_b32 v17, 0xffff0000, v53
    v_pk_add_f32 v[10:11], v[10:11], v[16:17]
    v_lshlrev_b32 v16, 16, v54
    v_and_b32 v17, 0xffff0000, v54
    v_pk_add_f32 v[12:13], v[12:13], v[16:17]
    v_lshlrev_b32 v16, 16, v55
    v_and_b32 v17, 0xffff0000, v55
    v_pk_add_f32 v[14:15], v[14:15], v[16:17]
    s_waitcnt vmcnt(7)
    v_lshlrev_b32 v16, 16, v56
    v_and_b32 v17, 0xffff0000, v56
    v_pk_add_f32 v[8:9], v[8:9], v[16:17]
    v_lshlrev_b32 v16, 16, v57
    v_and_b32 v17, 0xffff0000, v57
    v_pk_add_f32 v[10:11], v[10:11], v[16:17]
    v_lshlrev_b32 v16, 16, v58
    v_and_b32 v17, 0xffff0000, v58
    v_pk_add_f32 v[12:13], v[12:13], v[16:17]
    v_lshlrev_b32 v16, 16, v59
    v_and_b32 v17, 0xffff0000, v59
    v_pk_add_f32 v[14:15], v[14:15], v[16:17]
    s_waitcnt vmcnt(6)
    v_lshlrev_b32 v16, 16, v60
    v_and_b32 v17, 0xffff0000, v60
    v_pk_add_f32 v[8:9], v[8:9], v[16:17]
    v_lshlrev_b32 v16, 16, v61
    v_and_b32 v17, 0xffff0000, v61
    v_pk_add_f32 v[10:11], v[10:11], v[16:17]
    v_lshlrev_b32 v16, 16, v62
    v_and_b32 v17, 0xffff0000, v62
    v_pk_add_f32 v[12:13], v[12:13], v[16:17]
    v_lshlrev_b32 v16, 16, v63
    v_and_b32 v17, 0xffff0000, v63
    v_pk_add_f32 v[14:15], v[14:15], v[16:17]
    s_waitcnt vmcnt(5)
    v_lshlrev_b32 v16, 16, v64
    v_and_b32 v17, 0xffff0000, v64
    v_pk_add_f32 v[8:9], v[8:9], v[16:17]
    v_lshlrev_b32 v16, 16, v65
    v_and_b32 v17, 0xffff0000, v65
    v_pk_add_f32 v[10:11], v[10:11], v[16:17]
    v_lshlrev_b32 v16, 16, v66
    v_and_b32 v17, 0xffff0000, v66
    v_pk_add_f32 v[12:13], v[12:13], v[16:17]
    v_lshlrev_b32 v16, 16, v67
    v_and_b32 v17, 0xffff0000, v67
    v_pk_add_f32 v[14:15], v[14:15], v[16:17]
    s_waitcnt vmcnt(4)
    v_lshlrev_b32 v16, 16, v68
    v_and_b32 v17, 0xffff0000, v68
    v_pk_add_f32 v[8:9], v[8:9], v[16:17]
    v_lshlrev_b32 v16, 16, v69
    v_and_b32 v17, 0xffff0000, v69
    v_pk_add_f32 v[10:11], v[10:11], v[16:17]
    v_lshlrev_b32 v16, 16, v70
    v_and_b32 v17, 0xffff0000, v70
    v_pk_add_f32 v[12:13], v[12:13], v[16:17]
    v_lshlrev_b32 v16, 16, v71
    v_and_b32 v17, 0xffff0000, v71
    v_pk_add_f32 v[14:15], v[14:15], v[16:17]
    s_waitcnt vmcnt(3)
    v_lshlrev_b32 v16, 16, v72
    v_and_b32 v17, 0xffff0000, v72
    v_pk_add_f32 v[8:9], v[8:9], v[16:17]
    v_lshlrev_b32 v16, 16, v73
    v_and_b32 v17, 0xffff0000, v73
    v_pk_add_f32 v[10:11], v[10:11], v[16:17]
    v_lshlrev_b32 v16, 16, v74
    v_and_b32 v17, 0xffff0000, v74
    v_pk_add_f32 v[12:13], v[12:13], v[16:17]
    v_lshlrev_b32 v16, 16, v75
    v_and_b32 v17, 0xffff0000, v75
    v_pk_add_f32 v[14:15], v[14:15], v[16:17]
    s_waitcnt vmcnt(2)
    v_lshlrev_b32 v16, 16, v76
    v_and_b32 v17, 0xffff0000, v76
    v_pk_add_f32 v[8:9], v[8:9], v[16:17]
    v_lshlrev_b32 v16, 16, v77
    v_and_b32 v17, 0xffff0000, v77
    v_pk_add_f32 v[10:11], v[10:11], v[16:17]
    v_lshlrev_b32 v16, 16, v78
    v_and_b32 v17, 0xffff0000, v78
    v_pk_add_f32 v[12:13], v[12:13], v[16:17]
    v_lshlrev_b32 v16, 16, v79
    v_and_b32 v17, 0xffff0000, v79
    v_pk_add_f32 v[14:15], v[14:15], v[16:17]
    s_waitcnt vmcnt(1)
    v_lshlrev_b32 v16, 16, v80
    v_and_b32 v17, 0xffff0000, v80
    v_pk_add_f32 v[8:9], v[8:9], v[16:17]
    v_lshlrev_b32 v16, 16, v81
    v_and_b32 v17, 0xffff0000, v81
    v_pk_add_f32 v[10:11], v[10:11], v[16:17]
    v_lshlrev_b32 v16, 16, v82
    v_and_b32 v17, 0xffff0000, v82
    v_pk_add_f32 v[12:13], v[12:13], v[16:17]
    v_lshlrev_b32 v16, 16, v83
    v_and_b32 v17, 0xffff0000, v83
    v_pk_add_f32 v[14:15], v[14:15], v[16:17]
    s_waitcnt vmcnt(0)
    v_lshlrev_b32 v16, 16, v84
    v_and_b32 v17, 0xffff0000, v84
    v_pk_add_f32 v[8:9], v[8:9], v[16:17]
    v_lshlrev_b32 v16, 16, v85
    v_and_b32 v17, 0xffff0000, v85
    v_pk_add_f32 v[10:11], v[10:11], v[16:17]
    v_lshlrev_b32 v16, 16, v86
    v_and_b32 v17, 0xffff0000, v86
    v_pk_add_f32 v[12:13], v[12:13], v[16:17]
    v_lshlrev_b32 v16, 16, v87
    v_and_b32 v17, 0xffff0000, v87
    v_pk_add_f32 v[14:15], v[14:15], v[16:17]
    v_lshlrev_b32 v18, 8, v2
    v_lshl_add_u32 v18, v1, 5, v18
    ds_write_b128 v18, v[8:11]
    ds_write_b128 v18, v[12:15] offset:16
    s_waitcnt lgkmcnt(0)
    s_barrier
    v_cmp_gt_u32 vcc, 64, v0
    s_and_saveexec_b64 s[34:35], vcc
    s_cbranch_execz K2_END
    v_lshlrev_b32 v18, 2, v0
    ds_read_b32 v32, v18 offset:0
    ds_read_b32 v33, v18 offset:256
    ds_read_b32 v34, v18 offset:512
    ds_read_b32 v35, v18 offset:768
    ds_read_b32 v36, v18 offset:1024
    ds_read_b32 v37, v18 offset:1280
    ds_read_b32 v38, v18 offset:1536
    ds_read_b32 v39, v18 offset:1792
    ds_read_b32 v40, v18 offset:2048
    ds_read_b32 v41, v18 offset:2304
    ds_read_b32 v42, v18 offset:2560
    ds_read_b32 v43, v18 offset:2816
    ds_read_b32 v44, v18 offset:3072
    ds_read_b32 v45, v18 offset:3328
    ds_read_b32 v46, v18 offset:3584
    ds_read_b32 v47, v18 offset:3840
    ds_read_b32 v48, v18 offset:4096
    ds_read_b32 v49, v18 offset:4352
    ds_read_b32 v50, v18 offset:4608
    ds_read_b32 v51, v18 offset:4864
    ds_read_b32 v52, v18 offset:5120
    ds_read_b32 v53, v18 offset:5376
    ds_read_b32 v54, v18 offset:5632
    ds_read_b32 v55, v18 offset:5888
    ds_read_b32 v56, v18 offset:6144
    ds_read_b32 v57, v18 offset:6400
    ds_read_b32 v58, v18 offset:6656
    ds_read_b32 v59, v18 offset:6912
    ds_read_b32 v60, v18 offset:7168
    ds_read_b32 v61, v18 offset:7424
    ds_read_b32 v62, v18 offset:7680
    ds_read_b32 v63, v18 offset:7936
    s_waitcnt lgkmcnt(0)
    v_add_f32 v32, v32, v48
    v_add_f32 v33, v33, v49
    v_add_f32 v34, v34, v50
    v_add_f32 v35, v35, v51
    v_add_f32 v36, v36, v52
    v_add_f32 v37, v37, v53
    v_add_f32 v38, v38, v54
    v_add_f32 v39, v39, v55
    v_add_f32 v40, v40, v56
    v_add_f32 v41, v41, v57
    v_add_f32 v42, v42, v58
    v_add_f32 v43, v43, v59
    v_add_f32 v44, v44, v60
    v_add_f32 v45, v45, v61
    v_add_f32 v46, v46, v62
    v_add_f32 v47, v47, v63
    v_add_f32 v32, v32, v40
    v_add_f32 v33, v33, v41
    v_add_f32 v34, v34, v42
    v_add_f32 v35, v35, v43
    v_add_f32 v36, v36, v44
    v_add_f32 v37, v37, v45
    v_add_f32 v38, v38, v46
    v_add_f32 v39, v39, v47
    v_add_f32 v32, v32, v36
    v_add_f32 v33, v33, v37
    v_add_f32 v34, v34, v38
    v_add_f32 v35, v35, v39
    v_add_f32 v32, v32, v34
    v_add_f32 v33, v33, v35
    v_add_f32 v32, v32, v33
    s_lshl_b32 s31, s3, 8
    buffer_store_dword v32, v18, s[16:19], s31 offen
K2_END:
    s_endpgm
.globl k3_kernel
.p2align 8
.type k3_kernel,@function
k3_kernel:
    s_cmp_ge_u32 s2, 240
    s_cbranch_scc1 K3_END
    s_cmp_lt_u32 s2, 16
    s_cbranch_scc1 K3_STAT
    s_sub_u32 s2, s2, 16
    s_load_dwordx4 s[4:7], s[0:1], 80
    s_load_dwordx2 s[8:9], s[0:1], 120
    s_load_dwordx2 s[60:61], s[0:1], 112
    v_lshrrev_b32 v1, 6, v0
    v_and_b32 v2, 63, v0
    s_and_b32 s10, s2, 7
    s_lshr_b32 s11, s2, 3
    v_readfirstlane_b32 s3, v1
    s_mul_i32 s12, s11, 37
    s_lshr_b32 s12, s12, 8
    s_mul_i32 s13, s12, 7
    s_sub_u32 s11, s11, s13
    s_and_b32 s13, s10, 1
    s_mul_i32 s13, s13, 7
    s_add_u32 s11, s11, s13
    s_lshr_b32 s10, s10, 1
    s_lshl_b32 s10, s10, 2
    s_add_u32 s10, s10, s12
    s_and_b32 s14, s3, 3
    s_lshr_b32 s15, s3, 2
    v_lshrrev_b32 v3, 4, v2
    v_bfe_u32 v4, v2, 2, 2
    v_xor_b32 v4, v4, v3
    v_and_b32 v5, 3, v2
    v_lshl_add_u32 v4, v4, 2, v5
    v_lshlrev_b32 v4, 4, v4
    v_mul_u32_u24 v5, 3584, v3
    v_add_u32 v5, v5, v4
    v_mul_u32_u24 v6, 4352, v3
    v_add_u32 v6, v6, v4
    s_lshl_b32 s36, s3, 2
    s_mul_i32 s37, s36, 3584
    s_lshl_b32 s38, s11, 8
    s_add_u32 s37, s37, s38
    s_mul_i32 s39, s36, 4352
    s_lshl_b32 s38, s10, 8
    s_add_u32 s39, s39, s38
    s_sub_u32 s39, s39, 139264
    s_lshl_b32 s40, s3, 10
    v_lshrrev_b32 v7, 5, v2
    v_lshlrev_b32 v8, 4, v7
    s_lshl_b32 s41, s11, 9
    s_lshl_b32 s42, s14, 7
    s_add_u32 s41, s41, s42
    s_add_u32 s42, s41, 7168
    v_lshrrev_b32 v9, 4, v2
    v_bfe_u32 v10, v2, 2, 2
    v_and_b32 v11, 3, v2
    v_lshrrev_b32 v12, 1, v9
    v_lshl_add_u32 v12, v12, 3, v10
    v_lshlrev_b32 v12, 8, v12
    v_and_b32 v9, 1, v9
    v_lshl_add_u32 v12, v9, 5, v12
    v_lshl_add_u32 v12, v11, 3, v12
    v_xor_b32 v13, s14, v10
    v_lshl_add_u32 v16, v13, 6, v12
    s_and_b32 s44, s14, 1
    s_lshl_b32 s45, s15, 1
    s_add_u32 s46, s45, s44
    s_xor_b32 s47, s46, 1
    v_xor_b32 v13, s46, v10
    v_lshl_add_u32 v17, v13, 6, v12
    v_xor_b32 v13, s47, v10
    v_lshl_add_u32 v18, v13, 6, v12
    v_add_u32 v17, 16384, v17
    v_add_u32 v18, 16384, v18
    v_add_u32 v19, 49152, v16
    v_add_u32 v20, 49152, v17
    v_add_u32 v21, 49152, v18
    v_add_u32 v22, 98304, v16
    v_add_u32 v23, 98304, v17
    v_add_u32 v24, 98304, v18
    v_lshrrev_b32 v9, 4, v0
    v_bfe_u32 v10, v0, 2, 2
    v_and_b32 v11, 3, v9
    v_xor_b32 v10, v10, v11
    v_and_b32 v11, 3, v0
    v_lshl_add_u32 v10, v10, 2, v11
    v_lshlrev_b32 v10, 4, v10
    v_lshl_add_u32 v10, v9, 8, v10
    v_add_u32 v192, 16384, v10
    v_add_u32 v193, 65536, v10
    v_add_u32 v194, 114688, v10
    v_mov_b32 v196, 0
    v_mov_b32 v197, 0
    v_mov_b32 v198, 0
    v_mov_b32 v199, 0
    v_mov_b32 v200, 0
    v_mov_b32 v201, 0
    v_mov_b32 v202, 0
    v_mov_b32 v203, 0
    v_mov_b32 v204, 0
    v_mov_b32 v205, 0
    v_mov_b32 v206, 0
    v_mov_b32 v207, 0
    v_mov_b32 v208, 0
    v_mov_b32 v209, 0
    v_mov_b32 v210, 0
    v_mov_b32 v211, 0
    s_waitcnt lgkmcnt(0)
    s_mov_b32 s16, s4
    s_mov_b32 s17, s5
    s_mov_b32 s18, 1605632
    s_mov_b32 s19, 0x00020000
    s_mov_b32 s20, s6
    s_mov_b32 s21, s7
    s_mov_b32 s22, 1605632
    s_mov_b32 s23, 0x00020000
    s_add_u32 s24, s8, 5963776
    s_addc_u32 s25, s9, 0
    s_mov_b32 s26, 1949696
    s_mov_b32 s27, 0x00020000
    s_add_u32 s28, s8, 7913472
    s_addc_u32 s29, s9, 0
    s_mov_b32 s30, 14336
    s_mov_b32 s31, 0x00020000
    s_add_u32 s32, s8, 7946240
    s_addc_u32 s33, s9, 0
    s_mov_b32 s34, 7569408
    s_mov_b32 s35, 0x00020000
    s_add_u32 s64, s8, 7929856
    s_addc_u32 s65, s9, 0
    s_mov_b32 s66, 16384
    s_mov_b32 s67, 0x00020000
    s_add_u32 m0, s40, 0
    s_add_u32 s39, s39, 139264
    buffer_load_dwordx4 v5, s[16:19], s37 offen lds
    s_add_u32 m0, m0, 8192
    s_nop 0
    buffer_load_dwordx4 v5, s[20:23], s37 offen lds
    s_add_u32 m0, m0, 8192
    s_add_u32 s37, s37, 114688
    buffer_load_dwordx4 v6, s[24:27], s39 offen lds
    s_add_u32 m0, s40, 24576
    s_add_u32 s39, s39, 139264
    buffer_load_dwordx4 v5, s[16:19], s37 offen lds
    s_add_u32 m0, m0, 8192
    s_nop 0
    buffer_load_dwordx4 v5, s[20:23], s37 offen lds
    s_add_u32 m0, m0, 8192
    s_add_u32 s37, s37, 114688
    buffer_load_dwordx4 v6, s[24:27], s39 offen lds
    s_cmp_ge_u32 s3, 4
    s_cselect_b64 vcc, -1, 0
    s_waitcnt vmcnt(3)
    s_barrier
    ds_read_b64_tr_b16 v[96:97], v16 offset:0
    ds_read_b64_tr_b16 v[98:99], v16 offset:1024
    ds_read_b64_tr_b16 v[104:105], v17 offset:0
    ds_read_b64_tr_b16 v[106:107], v17 offset:1024
    ds_read_b64_tr_b16 v[100:101], v16 offset:8192
    ds_read_b64_tr_b16 v[102:103], v16 offset:9216
    ds_read_b64_tr_b16 v[108:109], v18 offset:0
    ds_read_b64_tr_b16 v[110:111], v18 offset:1024
    s_cbranch_vccz K3_BB0
    s_waitcnt vmcnt(0)
    s_barrier
K3_BB0:
    s_waitcnt lgkmcnt(4)
    v_mfma_f32_32x32x16_bf16 v[32:47], v[96:99], v[104:107], 0
    ds_read_b64_tr_b16 v[112:113], v16 offset:4096
    ds_read_b64_tr_b16 v[114:115], v16 offset:5120
    s_waitcnt lgkmcnt(4)
    v_mfma_f32_32x32x16_bf16 v[48:63], v[100:103], v[104:107], 0
    ds_read_b64_tr_b16 v[120:121], v17 offset:4096
    ds_read_b64_tr_b16 v[122:123], v17 offset:5120
    s_waitcnt lgkmcnt(4)
    v_mfma_f32_32x32x16_bf16 v[64:79], v[96:99], v[108:111], 0
    ds_read_b64_tr_b16 v[116:117], v16 offset:12288
    ds_read_b64_tr_b16 v[118:119], v16 offset:13312
    v_mfma_f32_32x32x16_bf16 v[80:95], v[100:103], v[108:111], 0
    ds_read_b64_tr_b16 v[124:125], v18 offset:4096
    ds_read_b64_tr_b16 v[126:127], v18 offset:5120
    s_cbranch_vccnz K3_BA0
    s_waitcnt vmcnt(0)
    s_barrier
K3_BA0:
    s_add_u32 m0, s40, 49152
    s_add_u32 s39, s39, 139264
    buffer_load_dwordx4 v5, s[16:19], s37 offen lds
    s_add_u32 m0, m0, 8192
    s_nop 0
    buffer_load_dwordx4 v5, s[20:23], s37 offen lds
    s_add_u32 m0, m0, 8192
    s_add_u32 s37, s37, 114688
    buffer_load_dwordx4 v6, s[24:27], s39 offen lds
    s_add_u32 m0, s40, 73728
    s_add_u32 s39, s39, 139264
    buffer_load_dwordx4 v5, s[16:19], s37 offen lds
    s_add_u32 m0, m0, 8192
    s_nop 0
    buffer_load_dwordx4 v5, s[20:23], s37 offen lds
    s_add_u32 m0, m0, 8192
    s_add_u32 s37, s37, 114688
    buffer_load_dwordx4 v6, s[24:27], s39 offen lds
    s_waitcnt lgkmcnt(4)
    v_mfma_f32_32x32x16_bf16 v[32:47], v[112:115], v[120:123], v[32:47]
    ds_read_b64_tr_b16 v[96:97], v16 offset:24576
    ds_read_b64_tr_b16 v[98:99], v16 offset:25600
    s_waitcnt lgkmcnt(4)
    v_mfma_f32_32x32x16_bf16 v[48:63], v[116:119], v[120:123], v[48:63]
    ds_read_b64_tr_b16 v[104:105], v17 offset:24576
    ds_read_b64_tr_b16 v[106:107], v17 offset:25600
    s_waitcnt lgkmcnt(4)
    v_mfma_f32_32x32x16_bf16 v[64:79], v[112:115], v[124:127], v[64:79]
    ds_read_b64_tr_b16 v[100:101], v16 offset:32768
    ds_read_b64_tr_b16 v[102:103], v16 offset:33792
    v_mfma_f32_32x32x16_bf16 v[80:95], v[116:119], v[124:127], v[80:95]
    ds_read_b64_tr_b16 v[108:109], v18 offset:24576
    ds_read_b64_tr_b16 v[110:111], v18 offset:25600
    s_cbranch_vccz K3_BB1
    s_waitcnt vmcnt(3)
    s_barrier
K3_BB1:
    s_waitcnt lgkmcnt(4)
    v_mfma_f32_32x32x16_bf16 v[32:47], v[96:99], v[104:107], v[32:47]
    ds_read_b64_tr_b16 v[112:113], v16 offset:28672
    ds_read_b64_tr_b16 v[114:115], v16 offset:29696
    s_waitcnt lgkmcnt(4)
    v_mfma_f32_32x32x16_bf16 v[48:63], v[100:103], v[104:107], v[48:63]
    ds_read_b64_tr_b16 v[120:121], v17 offset:28672
    ds_read_b64_tr_b16 v[122:123], v17 offset:29696
    s_waitcnt lgkmcnt(4)
    v_mfma_f32_32x32x16_bf16 v[64:79], v[96:99], v[108:111], v[64:79]
    ds_read_b64_tr_b16 v[116:117], v16 offset:36864
    ds_read_b64_tr_b16 v[118:119], v16 offset:37888
    v_mfma_f32_32x32x16_bf16 v[80:95], v[100:103], v[108:111], v[80:95]
    ds_read_b64_tr_b16 v[124:125], v18 offset:28672
    ds_read_b64_tr_b16 v[126:127], v18 offset:29696
    s_cbranch_vccnz K3_BA1
    s_waitcnt vmcnt(3)
    s_barrier
K3_BA1:
    s_add_u32 m0, s40, 98304
    s_add_u32 s39, s39, 139264
    buffer_load_dwordx4 v5, s[16:19], s37 offen lds
    s_add_u32 m0, m0, 8192
    s_nop 0
    buffer_load_dwordx4 v5, s[20:23], s37 offen lds
    s_add_u32 m0, m0, 8192
    s_add_u32 s37, s37, 114688
    buffer_load_dwordx4 v6, s[24:27], s39 offen lds
    s_add_u32 m0, s40, 122880
    s_add_u32 s39, s39, 139264
    buffer_load_dwordx4 v5, s[16:19], s37 offen lds
    s_add_u32 m0, m0, 8192
    s_nop 0
    buffer_load_dwordx4 v5, s[20:23], s37 offen lds
    s_add_u32 m0, m0, 8192
    s_add_u32 s37, s37, 114688
    buffer_load_dwordx4 v6, s[24:27], s39 offen lds
    s_waitcnt lgkmcnt(4)
    v_mfma_f32_32x32x16_bf16 v[32:47], v[112:115], v[120:123], v[32:47]
    ds_read_b64_tr_b16 v[96:97], v19 offset:0
    ds_read_b64_tr_b16 v[98:99], v19 offset:1024
    s_waitcnt lgkmcnt(4)
    v_mfma_f32_32x32x16_bf16 v[48:63], v[116:119], v[120:123], v[48:63]
    ds_read_b64_tr_b16 v[104:105], v20 offset:0
    ds_read_b64_tr_b16 v[106:107], v20 offset:1024
    s_waitcnt lgkmcnt(4)
    v_mfma_f32_32x32x16_bf16 v[64:79], v[112:115], v[124:127], v[64:79]
    ds_read_b64_tr_b16 v[100:101], v19 offset:8192
    ds_read_b64_tr_b16 v[102:103], v19 offset:9216
    v_mfma_f32_32x32x16_bf16 v[80:95], v[116:119], v[124:127], v[80:95]
    ds_read_b64_tr_b16 v[108:109], v21 offset:0
    ds_read_b64_tr_b16 v[110:111], v21 offset:1024
    s_cbranch_vccz K3_BB2
    s_waitcnt vmcnt(6)
    s_barrier
K3_BB2:
    s_waitcnt lgkmcnt(4)
    v_mfma_f32_32x32x16_bf16 v[32:47], v[96:99], v[104:107], v[32:47]
    ds_read_b64_tr_b16 v[112:113], v19 offset:4096
    ds_read_b64_tr_b16 v[114:115], v19 offset:5120
    s_waitcnt lgkmcnt(4)
    v_mfma_f32_32x32x16_bf16 v[48:63], v[100:103], v[104:107], v[48:63]
    ds_read_b64_tr_b16 v[120:121], v20 offset:4096
    ds_read_b64_tr_b16 v[122:123], v20 offset:5120
    s_waitcnt lgkmcnt(4)
    v_mfma_f32_32x32x16_bf16 v[64:79], v[96:99], v[108:111], v[64:79]
    ds_read_b64_tr_b16 v[116:117], v19 offset:12288
    ds_read_b64_tr_b16 v[118:119], v19 offset:13312
    v_mfma_f32_32x32x16_bf16 v[80:95], v[100:103], v[108:111], v[80:95]
    ds_read_b64_tr_b16 v[124:125], v21 offset:4096
    ds_read_b64_tr_b16 v[126:127], v21 offset:5120
    s_cbranch_vccnz K3_BA2
    s_waitcnt vmcnt(6)
    s_barrier
K3_BA2:
    s_add_u32 m0, s40, 0
    s_add_u32 s39, s39, 139264
    buffer_load_dwordx4 v5, s[16:19], s37 offen lds
    s_add_u32 m0, m0, 8192
    s_nop 0
    buffer_load_dwordx4 v5, s[20:23], s37 offen lds
    s_add_u32 m0, m0, 8192
    s_add_u32 s37, s37, 114688
    buffer_load_dwordx4 v6, s[24:27], s39 offen lds
    s_add_u32 m0, s40, 24576
    s_add_u32 s39, s39, 139264
    buffer_load_dwordx4 v5, s[16:19], s37 offen lds
    s_add_u32 m0, m0, 8192
    s_nop 0
    buffer_load_dwordx4 v5, s[20:23], s37 offen lds
    s_add_u32 m0, m0, 8192
    s_add_u32 s37, s37, 114688
    buffer_load_dwordx4 v6, s[24:27], s39 offen lds
    s_waitcnt lgkmcnt(4)
    v_mfma_f32_32x32x16_bf16 v[32:47], v[112:115], v[120:123], v[32:47]
    ds_read_b64_tr_b16 v[96:97], v19 offset:24576
    ds_read_b64_tr_b16 v[98:99], v19 offset:25600
    s_waitcnt lgkmcnt(4)
    v_mfma_f32_32x32x16_bf16 v[48:63], v[116:119], v[120:123], v[48:63]
    ds_read_b64_tr_b16 v[104:105], v20 offset:24576
    ds_read_b64_tr_b16 v[106:107], v20 offset:25600
    s_waitcnt lgkmcnt(4)
    v_mfma_f32_32x32x16_bf16 v[64:79], v[112:115], v[124:127], v[64:79]
    ds_read_b64_tr_b16 v[100:101], v19 offset:32768
    ds_read_b64_tr_b16 v[102:103], v19 offset:33792
    v_mfma_f32_32x32x16_bf16 v[80:95], v[116:119], v[124:127], v[80:95]
    ds_read_b64_tr_b16 v[108:109], v21 offset:24576
    ds_read_b64_tr_b16 v[110:111], v21 offset:25600
    s_cbranch_vccz K3_BB3
    s_waitcnt vmcnt(9)
    s_barrier
K3_BB3:
    s_waitcnt lgkmcnt(4)
    v_mfma_f32_32x32x16_bf16 v[32:47], v[96:99], v[104:107], v[32:47]
    ds_read_b64_tr_b16 v[112:113], v19 offset:28672
    ds_read_b64_tr_b16 v[114:115], v19 offset:29696
    s_waitcnt lgkmcnt(4)
    v_mfma_f32_32x32x16_bf16 v[48:63], v[100:103], v[104:107], v[48:63]
    ds_read_b64_tr_b16 v[120:121], v20 offset:28672
    ds_read_b64_tr_b16 v[122:123], v20 offset:29696
    s_waitcnt lgkmcnt(4)
    v_mfma_f32_32x32x16_bf16 v[64:79], v[96:99], v[108:111], v[64:79]
    ds_read_b64_tr_b16 v[116:117], v19 offset:36864
    ds_read_b64_tr_b16 v[118:119], v19 offset:37888
    v_mfma_f32_32x32x16_bf16 v[80:95], v[100:103], v[108:111], v[80:95]
    ds_read_b64_tr_b16 v[124:125], v21 offset:28672
    ds_read_b64_tr_b16 v[126:127], v21 offset:29696
    s_cbranch_vccnz K3_BA3
    s_waitcnt vmcnt(9)
    s_barrier
K3_BA3:
    s_add_u32 m0, s40, 49152
    s_add_u32 s39, s39, 139264
    buffer_load_dwordx4 v5, s[16:19], s37 offen lds
    s_add_u32 m0, m0, 8192
    s_nop 0
    buffer_load_dwordx4 v5, s[20:23], s37 offen lds
    s_add_u32 m0, m0, 8192
    s_add_u32 s37, s37, 114688
    buffer_load_dwordx4 v6, s[24:27], s39 offen lds
    s_waitcnt lgkmcnt(4)
    v_mfma_f32_32x32x16_bf16 v[32:47], v[112:115], v[120:123], v[32:47]
    ds_read_b64_tr_b16 v[96:97], v22 offset:0
    ds_read_b64_tr_b16 v[98:99], v22 offset:1024
    s_waitcnt lgkmcnt(4)
    v_mfma_f32_32x32x16_bf16 v[48:63], v[116:119], v[120:123], v[48:63]
    ds_read_b64_tr_b16 v[104:105], v23 offset:0
    ds_read_b64_tr_b16 v[106:107], v23 offset:1024
    s_waitcnt lgkmcnt(4)
    v_mfma_f32_32x32x16_bf16 v[64:79], v[112:115], v[124:127], v[64:79]
    ds_read_b64_tr_b16 v[100:101], v22 offset:8192
    ds_read_b64_tr_b16 v[102:103], v22 offset:9216
    v_mfma_f32_32x32x16_bf16 v[80:95], v[116:119], v[124:127], v[80:95]
    ds_read_b64_tr_b16 v[108:109], v24 offset:0
    ds_read_b64_tr_b16 v[110:111], v24 offset:1024
    s_cbranch_vccz K3_BB4
    s_waitcnt vmcnt(9)
    s_barrier
K3_BB4:
    s_waitcnt lgkmcnt(4)
    v_mfma_f32_32x32x16_bf16 v[32:47], v[96:99], v[104:107], v[32:47]
    ds_read_b64_tr_b16 v[112:113], v22 offset:4096
    ds_read_b64_tr_b16 v[114:115], v22 offset:5120
    s_waitcnt lgkmcnt(4)
    v_mfma_f32_32x32x16_bf16 v[48:63], v[100:103], v[104:107], v[48:63]
    ds_read_b64_tr_b16 v[120:121], v23 offset:4096
    ds_read_b64_tr_b16 v[122:123], v23 offset:5120
    s_waitcnt lgkmcnt(4)
    v_mfma_f32_32x32x16_bf16 v[64:79], v[96:99], v[108:111], v[64:79]
    ds_read_b64_tr_b16 v[116:117], v22 offset:12288
    ds_read_b64_tr_b16 v[118:119], v22 offset:13312
    v_mfma_f32_32x32x16_bf16 v[80:95], v[100:103], v[108:111], v[80:95]
    ds_read_b64_tr_b16 v[124:125], v24 offset:4096
    ds_read_b64_tr_b16 v[126:127], v24 offset:5120
    s_cbranch_vccnz K3_BA4
    s_waitcnt vmcnt(9)
    s_barrier
K3_BA4:
    s_add_u32 m0, s40, 73728
    s_add_u32 s39, s39, 139264
    buffer_load_dwordx4 v5, s[16:19], s37 offen lds
    s_add_u32 m0, m0, 8192
    s_nop 0
    buffer_load_dwordx4 v5, s[20:23], s37 offen lds
    s_add_u32 m0, m0, 8192
    s_add_u32 s37, s37, 114688
    buffer_load_dwordx4 v6, s[24:27], s39 offen lds
    s_waitcnt lgkmcnt(4)
    v_mfma_f32_32x32x16_bf16 v[32:47], v[112:115], v[120:123], v[32:47]
    ds_read_b64_tr_b16 v[96:97], v22 offset:24576
    ds_read_b64_tr_b16 v[98:99], v22 offset:25600
    s_waitcnt lgkmcnt(4)
    v_mfma_f32_32x32x16_bf16 v[48:63], v[116:119], v[120:123], v[48:63]
    ds_read_b64_tr_b16 v[104:105], v23 offset:24576
    ds_read_b64_tr_b16 v[106:107], v23 offset:25600
    s_waitcnt lgkmcnt(4)
    v_mfma_f32_32x32x16_bf16 v[64:79], v[112:115], v[124:127], v[64:79]
    ds_read_b64_tr_b16 v[100:101], v22 offset:32768
    ds_read_b64_tr_b16 v[102:103], v22 offset:33792
    v_mfma_f32_32x32x16_bf16 v[80:95], v[116:119], v[124:127], v[80:95]
    ds_read_b64_tr_b16 v[108:109], v24 offset:24576
    ds_read_b64_tr_b16 v[110:111], v24 offset:25600
    s_cbranch_vccz K3_BB5
    s_waitcnt vmcnt(9)
    s_barrier
K3_BB5:
    s_waitcnt lgkmcnt(4)
    v_mfma_f32_32x32x16_bf16 v[32:47], v[96:99], v[104:107], v[32:47]
    ds_read_b64_tr_b16 v[112:113], v22 offset:28672
    ds_read_b64_tr_b16 v[114:115], v22 offset:29696
    s_waitcnt lgkmcnt(4)
    v_mfma_f32_32x32x16_bf16 v[48:63], v[100:103], v[104:107], v[48:63]
    ds_read_b64_tr_b16 v[120:121], v23 offset:28672
    ds_read_b64_tr_b16 v[122:123], v23 offset:29696
    s_waitcnt lgkmcnt(4)
    v_mfma_f32_32x32x16_bf16 v[64:79], v[96:99], v[108:111], v[64:79]
    ds_read_b64_tr_b16 v[116:117], v22 offset:36864
    ds_read_b64_tr_b16 v[118:119], v22 offset:37888
    v_mfma_f32_32x32x16_bf16 v[80:95], v[100:103], v[108:111], v[80:95]
    ds_read_b64_tr_b16 v[124:125], v24 offset:28672
    ds_read_b64_tr_b16 v[126:127], v24 offset:29696
    s_cbranch_vccnz K3_BA5
    s_waitcnt vmcnt(9)
    s_barrier
K3_BA5:
    s_add_u32 m0, s40, 98304
    s_add_u32 s39, s39, 139264
    buffer_load_dwordx4 v5, s[16:19], s37 offen lds
    s_add_u32 m0, m0, 8192
    s_nop 0
    buffer_load_dwordx4 v5, s[20:23], s37 offen lds
    s_add_u32 m0, m0, 8192
    s_add_u32 s37, s37, 114688
    buffer_load_dwordx4 v6, s[24:27], s39 offen lds
    s_waitcnt lgkmcnt(4)
    v_mfma_f32_32x32x16_bf16 v[32:47], v[112:115], v[120:123], v[32:47]
    ds_read_b64_tr_b16 v[96:97], v16 offset:0
    ds_read_b64_tr_b16 v[98:99], v16 offset:1024
    s_waitcnt lgkmcnt(4)
    v_mfma_f32_32x32x16_bf16 v[48:63], v[116:119], v[120:123], v[48:63]
    ds_read_b64_tr_b16 v[104:105], v17 offset:0
    ds_read_b64_tr_b16 v[106:107], v17 offset:1024
    s_waitcnt lgkmcnt(4)
    v_mfma_f32_32x32x16_bf16 v[64:79], v[112:115], v[124:127], v[64:79]
    ds_read_b64_tr_b16 v[100:101], v16 offset:8192
    ds_read_b64_tr_b16 v[102:103], v16 offset:9216
    v_mfma_f32_32x32x16_bf16 v[80:95], v[116:119], v[124:127], v[80:95]
    ds_read_b64_tr_b16 v[108:109], v18 offset:0
    ds_read_b64_tr_b16 v[110:111], v18 offset:1024
    s_cbranch_vccz K3_BB6
    s_waitcnt vmcnt(9)
    s_barrier
K3_BB6:
    s_waitcnt lgkmcnt(4)
    v_mfma_f32_32x32x16_bf16 v[32:47], v[96:99], v[104:107], v[32:47]
    ds_read_b64_tr_b16 v[112:113], v16 offset:4096
    ds_read_b64_tr_b16 v[114:115], v16 offset:5120
    s_waitcnt lgkmcnt(4)
    v_mfma_f32_32x32x16_bf16 v[48:63], v[100:103], v[104:107], v[48:63]
    ds_read_b64_tr_b16 v[120:121], v17 offset:4096
    ds_read_b64_tr_b16 v[122:123], v17 offset:5120
    s_waitcnt lgkmcnt(4)
    v_mfma_f32_32x32x16_bf16 v[64:79], v[96:99], v[108:111], v[64:79]
    ds_read_b64_tr_b16 v[116:117], v16 offset:12288
    ds_read_b64_tr_b16 v[118:119], v16 offset:13312
    v_mfma_f32_32x32x16_bf16 v[80:95], v[100:103], v[108:111], v[80:95]
    ds_read_b64_tr_b16 v[124:125], v18 offset:4096
    ds_read_b64_tr_b16 v[126:127], v18 offset:5120
    s_cbranch_vccnz K3_BA6
    s_waitcnt vmcnt(9)
    s_barrier
K3_BA6:
    s_add_u32 m0, s40, 122880
    s_add_u32 s39, s39, 139264
    buffer_load_dwordx4 v5, s[16:19], s37 offen lds
    s_add_u32 m0, m0, 8192
    s_nop 0
    buffer_load_dwordx4 v5, s[20:23], s37 offen lds
    s_add_u32 m0, m0, 8192
    s_add_u32 s37, s37, 114688
    buffer_load_dwordx4 v6, s[24:27], s39 offen lds
    s_waitcnt lgkmcnt(4)
    v_mfma_f32_32x32x16_bf16 v[32:47], v[112:115], v[120:123], v[32:47]
    ds_read_b64_tr_b16 v[96:97], v16 offset:24576
    ds_read_b64_tr_b16 v[98:99], v16 offset:25600
    s_waitcnt lgkmcnt(4)
    v_mfma_f32_32x32x16_bf16 v[48:63], v[116:119], v[120:123], v[48:63]
    ds_read_b64_tr_b16 v[104:105], v17 offset:24576
    ds_read_b64_tr_b16 v[106:107], v17 offset:25600
    s_waitcnt lgkmcnt(4)
    v_mfma_f32_32x32x16_bf16 v[64:79], v[112:115], v[124:127], v[64:79]
    ds_read_b64_tr_b16 v[100:101], v16 offset:32768
    ds_read_b64_tr_b16 v[102:103], v16 offset:33792
    v_mfma_f32_32x32x16_bf16 v[80:95], v[116:119], v[124:127], v[80:95]
    ds_read_b64_tr_b16 v[108:109], v18 offset:24576
    ds_read_b64_tr_b16 v[110:111], v18 offset:25600
    s_cbranch_vccz K3_BB7
    s_waitcnt vmcnt(9)
    s_barrier
K3_BB7:
    s_waitcnt lgkmcnt(4)
    v_mfma_f32_32x32x16_bf16 v[32:47], v[96:99], v[104:107], v[32:47]
    ds_read_b64_tr_b16 v[112:113], v16 offset:28672
    ds_read_b64_tr_b16 v[114:115], v16 offset:29696
    s_waitcnt lgkmcnt(4)
    v_mfma_f32_32x32x16_bf16 v[48:63], v[100:103], v[104:107], v[48:63]
    ds_read_b64_tr_b16 v[120:121], v17 offset:28672
    ds_read_b64_tr_b16 v[122:123], v17 offset:29696
    s_waitcnt lgkmcnt(4)
    v_mfma_f32_32x32x16_bf16 v[64:79], v[96:99], v[108:111], v[64:79]
    ds_read_b64_tr_b16 v[116:117], v16 offset:36864
    ds_read_b64_tr_b16 v[118:119], v16 offset:37888
    v_mfma_f32_32x32x16_bf16 v[80:95], v[100:103], v[108:111], v[80:95]
    ds_read_b64_tr_b16 v[124:125], v18 offset:28672
    ds_read_b64_tr_b16 v[126:127], v18 offset:29696
    s_cbranch_vccnz K3_BA7
    s_waitcnt vmcnt(9)
    s_barrier
K3_BA7:
    s_add_u32 m0, s40, 0
    s_add_u32 s39, s39, 139264
    buffer_load_dwordx4 v5, s[16:19], s37 offen lds
    s_add_u32 m0, m0, 8192
    s_nop 0
    buffer_load_dwordx4 v5, s[20:23], s37 offen lds
    s_add_u32 m0, m0, 8192
    s_add_u32 s37, s37, 114688
    buffer_load_dwordx4 v6, s[24:27], s39 offen lds
    s_waitcnt lgkmcnt(4)
    v_mfma_f32_32x32x16_bf16 v[32:47], v[112:115], v[120:123], v[32:47]
    ds_read_b64_tr_b16 v[96:97], v19 offset:0
    ds_read_b64_tr_b16 v[98:99], v19 offset:1024
    s_waitcnt lgkmcnt(4)
    v_mfma_f32_32x32x16_bf16 v[48:63], v[116:119], v[120:123], v[48:63]
    ds_read_b64_tr_b16 v[104:105], v20 offset:0
    ds_read_b64_tr_b16 v[106:107], v20 offset:1024
    s_waitcnt lgkmcnt(4)
    v_mfma_f32_32x32x16_bf16 v[64:79], v[112:115], v[124:127], v[64:79]
    ds_read_b64_tr_b16 v[100:101], v19 offset:8192
    ds_read_b64_tr_b16 v[102:103], v19 offset:9216
    v_mfma_f32_32x32x16_bf16 v[80:95], v[116:119], v[124:127], v[80:95]
    ds_read_b64_tr_b16 v[108:109], v21 offset:0
    ds_read_b64_tr_b16 v[110:111], v21 offset:1024
    s_cbranch_vccz K3_BB8
    s_waitcnt vmcnt(9)
    s_barrier
K3_BB8:
    s_waitcnt lgkmcnt(4)
    v_mfma_f32_32x32x16_bf16 v[32:47], v[96:99], v[104:107], v[32:47]
    ds_read_b64_tr_b16 v[112:113], v19 offset:4096
    ds_read_b64_tr_b16 v[114:115], v19 offset:5120
    s_waitcnt lgkmcnt(4)
    v_mfma_f32_32x32x16_bf16 v[48:63], v[100:103], v[104:107], v[48:63]
    ds_read_b64_tr_b16 v[120:121], v20 offset:4096
    ds_read_b64_tr_b16 v[122:123], v20 offset:5120
    s_waitcnt lgkmcnt(4)
    v_mfma_f32_32x32x16_bf16 v[64:79], v[96:99], v[108:111], v[64:79]
    ds_read_b64_tr_b16 v[116:117], v19 offset:12288
    ds_read_b64_tr_b16 v[118:119], v19 offset:13312
    v_mfma_f32_32x32x16_bf16 v[80:95], v[100:103], v[108:111], v[80:95]
    ds_read_b64_tr_b16 v[124:125], v21 offset:4096
    ds_read_b64_tr_b16 v[126:127], v21 offset:5120
    s_cbranch_vccnz K3_BA8
    s_waitcnt vmcnt(9)
    s_barrier
K3_BA8:
    s_add_u32 m0, s40, 24576
    s_add_u32 s39, s39, 139264
    buffer_load_dwordx4 v5, s[16:19], s37 offen lds
    s_add_u32 m0, m0, 8192
    s_nop 0
    buffer_load_dwordx4 v5, s[20:23], s37 offen lds
    s_add_u32 m0, m0, 8192
    s_add_u32 s37, s37, 114688
    buffer_load_dwordx4 v6, s[24:27], s39 offen lds
    s_waitcnt lgkmcnt(4)
    v_mfma_f32_32x32x16_bf16 v[32:47], v[112:115], v[120:123], v[32:47]
    ds_read_b64_tr_b16 v[96:97], v19 offset:24576
    ds_read_b64_tr_b16 v[98:99], v19 offset:25600
    s_waitcnt lgkmcnt(4)
    v_mfma_f32_32x32x16_bf16 v[48:63], v[116:119], v[120:123], v[48:63]
    ds_read_b64_tr_b16 v[104:105], v20 offset:24576
    ds_read_b64_tr_b16 v[106:107], v20 offset:25600
    s_waitcnt lgkmcnt(4)
    v_mfma_f32_32x32x16_bf16 v[64:79], v[112:115], v[124:127], v[64:79]
    ds_read_b64_tr_b16 v[100:101], v19 offset:32768
    ds_read_b64_tr_b16 v[102:103], v19 offset:33792
    v_mfma_f32_32x32x16_bf16 v[80:95], v[116:119], v[124:127], v[80:95]
    ds_read_b64_tr_b16 v[108:109], v21 offset:24576
    ds_read_b64_tr_b16 v[110:111], v21 offset:25600
    s_cbranch_vccz K3_BB9
    s_waitcnt vmcnt(9)
    s_barrier
K3_BB9:
    s_waitcnt lgkmcnt(4)
    v_mfma_f32_32x32x16_bf16 v[32:47], v[96:99], v[104:107], v[32:47]
    ds_read_b64_tr_b16 v[112:113], v19 offset:28672
    ds_read_b64_tr_b16 v[114:115], v19 offset:29696
    s_waitcnt lgkmcnt(4)
    v_mfma_f32_32x32x16_bf16 v[48:63], v[100:103], v[104:107], v[48:63]
    ds_read_b64_tr_b16 v[120:121], v20 offset:28672
    ds_read_b64_tr_b16 v[122:123], v20 offset:29696
    s_waitcnt lgkmcnt(4)
    v_mfma_f32_32x32x16_bf16 v[64:79], v[96:99], v[108:111], v[64:79]
    ds_read_b64_tr_b16 v[116:117], v19 offset:36864
    ds_read_b64_tr_b16 v[118:119], v19 offset:37888
    v_mfma_f32_32x32x16_bf16 v[80:95], v[100:103], v[108:111], v[80:95]
    ds_read_b64_tr_b16 v[124:125], v21 offset:28672
    ds_read_b64_tr_b16 v[126:127], v21 offset:29696
    s_cbranch_vccnz K3_BA9
    s_waitcnt vmcnt(9)
    s_barrier
K3_BA9:
    s_lshl_b32 s49, s10, 2
    v_mov_b32 v10, s49
    global_load_dword v11, v10, s[60:61] sc1
    s_waitcnt lgkmcnt(4)
    v_mfma_f32_32x32x16_bf16 v[32:47], v[112:115], v[120:123], v[32:47]
    ds_read_b64_tr_b16 v[96:97], v22 offset:0
    ds_read_b64_tr_b16 v[98:99], v22 offset:1024
    s_waitcnt lgkmcnt(4)
    v_mfma_f32_32x32x16_bf16 v[48:63], v[116:119], v[120:123], v[48:63]
    ds_read_b64_tr_b16 v[104:105], v23 offset:0
    ds_read_b64_tr_b16 v[106:107], v23 offset:1024
    s_waitcnt lgkmcnt(4)
    v_mfma_f32_32x32x16_bf16 v[64:79], v[112:115], v[124:127], v[64:79]
    ds_read_b64_tr_b16 v[100:101], v22 offset:8192
    ds_read_b64_tr_b16 v[102:103], v22 offset:9216
    v_mfma_f32_32x32x16_bf16 v[80:95], v[116:119], v[124:127], v[80:95]
    ds_read_b64_tr_b16 v[108:109], v24 offset:0
    ds_read_b64_tr_b16 v[110:111], v24 offset:1024
    s_cbranch_vccz K3_BB10
    s_waitcnt vmcnt(7)
    s_barrier
K3_BB10:
    s_waitcnt lgkmcnt(4)
    v_mfma_f32_32x32x16_bf16 v[32:47], v[96:99], v[104:107], v[32:47]
    ds_read_b64_tr_b16 v[112:113], v22 offset:4096
    ds_read_b64_tr_b16 v[114:115], v22 offset:5120
    s_waitcnt lgkmcnt(4)
    v_mfma_f32_32x32x16_bf16 v[48:63], v[100:103], v[104:107], v[48:63]
    ds_read_b64_tr_b16 v[120:121], v23 offset:4096
    ds_read_b64_tr_b16 v[122:123], v23 offset:5120
    s_waitcnt lgkmcnt(4)
    v_mfma_f32_32x32x16_bf16 v[64:79], v[96:99], v[108:111], v[64:79]
    ds_read_b64_tr_b16 v[116:117], v22 offset:12288
    ds_read_b64_tr_b16 v[118:119], v22 offset:13312
    v_mfma_f32_32x32x16_bf16 v[80:95], v[100:103], v[108:111], v[80:95]
    ds_read_b64_tr_b16 v[124:125], v24 offset:4096
    ds_read_b64_tr_b16 v[126:127], v24 offset:5120
    s_cbranch_vccnz K3_BA10
    s_waitcnt vmcnt(7)
    s_barrier
K3_BA10:
    s_waitcnt lgkmcnt(4)
    v_mfma_f32_32x32x16_bf16 v[32:47], v[112:115], v[120:123], v[32:47]
    ds_read_b64_tr_b16 v[96:97], v22 offset:24576
    ds_read_b64_tr_b16 v[98:99], v22 offset:25600
    s_waitcnt lgkmcnt(4)
    v_mfma_f32_32x32x16_bf16 v[48:63], v[116:119], v[120:123], v[48:63]
    ds_read_b64_tr_b16 v[104:105], v23 offset:24576
    ds_read_b64_tr_b16 v[106:107], v23 offset:25600
    s_waitcnt lgkmcnt(4)
    v_mfma_f32_32x32x16_bf16 v[64:79], v[112:115], v[124:127], v[64:79]
    ds_read_b64_tr_b16 v[100:101], v22 offset:32768
    ds_read_b64_tr_b16 v[102:103], v22 offset:33792
    v_mfma_f32_32x32x16_bf16 v[80:95], v[116:119], v[124:127], v[80:95]
    ds_read_b64_tr_b16 v[108:109], v24 offset:24576
    ds_read_b64_tr_b16 v[110:111], v24 offset:25600
    s_cbranch_vccz K3_BB11
    s_waitcnt vmcnt(4)
    s_barrier
K3_BB11:
    s_waitcnt lgkmcnt(4)
    v_mfma_f32_32x32x16_bf16 v[32:47], v[96:99], v[104:107], v[32:47]
    ds_read_b64_tr_b16 v[112:113], v22 offset:28672
    ds_read_b64_tr_b16 v[114:115], v22 offset:29696
    s_waitcnt lgkmcnt(4)
    v_mfma_f32_32x32x16_bf16 v[48:63], v[100:103], v[104:107], v[48:63]
    ds_read_b64_tr_b16 v[120:121], v23 offset:28672
    ds_read_b64_tr_b16 v[122:123], v23 offset:29696
    s_waitcnt lgkmcnt(4)
    v_mfma_f32_32x32x16_bf16 v[64:79], v[96:99], v[108:111], v[64:79]
    ds_read_b64_tr_b16 v[116:117], v22 offset:36864
    ds_read_b64_tr_b16 v[118:119], v22 offset:37888
    v_mfma_f32_32x32x16_bf16 v[80:95], v[100:103], v[108:111], v[80:95]
    ds_read_b64_tr_b16 v[124:125], v24 offset:28672
    ds_read_b64_tr_b16 v[126:127], v24 offset:29696
    s_cbranch_vccnz K3_BA11
    s_waitcnt vmcnt(4)
    s_barrier
K3_BA11:
    s_waitcnt lgkmcnt(4)
    v_mfma_f32_32x32x16_bf16 v[32:47], v[112:115], v[120:123], v[32:47]
    ds_read_b64_tr_b16 v[96:97], v16 offset:0
    ds_read_b64_tr_b16 v[98:99], v16 offset:1024
    s_waitcnt lgkmcnt(4)
    v_mfma_f32_32x32x16_bf16 v[48:63], v[116:119], v[120:123], v[48:63]
    ds_read_b64_tr_b16 v[104:105], v17 offset:0
    ds_read_b64_tr_b16 v[106:107], v17 offset:1024
    s_waitcnt lgkmcnt(4)
    v_mfma_f32_32x32x16_bf16 v[64:79], v[112:115], v[124:127], v[64:79]
    ds_read_b64_tr_b16 v[100:101], v16 offset:8192
    ds_read_b64_tr_b16 v[102:103], v16 offset:9216
    v_mfma_f32_32x32x16_bf16 v[80:95], v[116:119], v[124:127], v[80:95]
    ds_read_b64_tr_b16 v[108:109], v18 offset:0
    ds_read_b64_tr_b16 v[110:111], v18 offset:1024
    s_cbranch_vccz K3_BB12
    s_waitcnt vmcnt(0)
    s_barrier
K3_BB12:
    s_waitcnt lgkmcnt(4)
    v_mfma_f32_32x32x16_bf16 v[32:47], v[96:99], v[104:107], v[32:47]
    ds_read_b64_tr_b16 v[112:113], v16 offset:4096
    ds_read_b64_tr_b16 v[114:115], v16 offset:5120
    s_waitcnt lgkmcnt(4)
    v_mfma_f32_32x32x16_bf16 v[48:63], v[100:103], v[104:107], v[48:63]
    ds_read_b64_tr_b16 v[120:121], v17 offset:4096
    ds_read_b64_tr_b16 v[122:123], v17 offset:5120
    s_waitcnt lgkmcnt(4)
    v_mfma_f32_32x32x16_bf16 v[64:79], v[96:99], v[108:111], v[64:79]
    ds_read_b64_tr_b16 v[116:117], v16 offset:12288
    ds_read_b64_tr_b16 v[118:119], v16 offset:13312
    v_mfma_f32_32x32x16_bf16 v[80:95], v[100:103], v[108:111], v[80:95]
    ds_read_b64_tr_b16 v[124:125], v18 offset:4096
    ds_read_b64_tr_b16 v[126:127], v18 offset:5120
    s_cbranch_vccnz K3_BA12
    s_waitcnt vmcnt(0)
    s_barrier
K3_BA12:
    v_readfirstlane_b32 s49, v11
    s_nop 3
    s_cmp_lg_u32 s49, 0
    s_cbranch_scc1 K3_PD
K3_POLL:
    s_sleep 2
    global_load_dword v11, v10, s[60:61] sc1
    s_waitcnt vmcnt(0)
    v_readfirstlane_b32 s49, v11
    s_nop 3
    s_cmp_lg_u32 s49, 0
    s_cbranch_scc0 K3_POLL
K3_PD:
    v_and_b32 v15, 31, v2
    v_lshlrev_b32 v12, 3, v15
    s_lshl_b32 s49, s10, 10
    s_lshl_b32 s62, s46, 8
    s_add_u32 s62, s62, s49
    buffer_load_dwordx2 v[200:201], v12, s[64:67], s62 offen sc1
    s_lshl_b32 s62, s47, 8
    s_add_u32 s62, s62, s49
    buffer_load_dwordx2 v[202:203], v12, s[64:67], s62 offen sc1
    buffer_load_dwordx4 v[160:163], v8, s[28:31], s41 offen offset:0
    buffer_load_dwordx4 v[176:179], v8, s[28:31], s42 offen offset:0
    buffer_load_dwordx4 v[164:167], v8, s[28:31], s41 offen offset:32
    buffer_load_dwordx4 v[180:183], v8, s[28:31], s42 offen offset:32
    buffer_load_dwordx4 v[168:171], v8, s[28:31], s41 offen offset:64
    buffer_load_dwordx4 v[184:187], v8, s[28:31], s42 offen offset:64
    buffer_load_dwordx4 v[172:175], v8, s[28:31], s41 offen offset:96
    buffer_load_dwordx4 v[188:191], v8, s[28:31], s42 offen offset:96
    s_waitcnt lgkmcnt(4)
    v_mfma_f32_32x32x16_bf16 v[32:47], v[112:115], v[120:123], v[32:47]
    ds_read_b64_tr_b16 v[96:97], v16 offset:24576
    ds_read_b64_tr_b16 v[98:99], v16 offset:25600
    s_waitcnt lgkmcnt(4)
    v_mfma_f32_32x32x16_bf16 v[48:63], v[116:119], v[120:123], v[48:63]
    ds_read_b64_tr_b16 v[104:105], v17 offset:24576
    ds_read_b64_tr_b16 v[106:107], v17 offset:25600
    s_waitcnt lgkmcnt(4)
    v_mfma_f32_32x32x16_bf16 v[64:79], v[112:115], v[124:127], v[64:79]
    ds_read_b64_tr_b16 v[100:101], v16 offset:32768
    ds_read_b64_tr_b16 v[102:103], v16 offset:33792
    v_mfma_f32_32x32x16_bf16 v[80:95], v[116:119], v[124:127], v[80:95]
    ds_read_b64_tr_b16 v[108:109], v18 offset:24576
    ds_read_b64_tr_b16 v[110:111], v18 offset:25600
    s_waitcnt lgkmcnt(4)
    v_mfma_f32_32x32x16_bf16 v[32:47], v[96:99], v[104:107], v[32:47]
    ds_read_b64_tr_b16 v[112:113], v16 offset:28672
    ds_read_b64_tr_b16 v[114:115], v16 offset:29696
    s_waitcnt lgkmcnt(4)
    v_mfma_f32_32x32x16_bf16 v[48:63], v[100:103], v[104:107], v[48:63]
    ds_read_b64_tr_b16 v[120:121], v17 offset:28672
    ds_read_b64_tr_b16 v[122:123], v17 offset:29696
    s_waitcnt lgkmcnt(4)
    v_mfma_f32_32x32x16_bf16 v[64:79], v[96:99], v[108:111], v[64:79]
    ds_read_b64_tr_b16 v[116:117], v16 offset:36864
    ds_read_b64_tr_b16 v[118:119], v16 offset:37888
    v_mfma_f32_32x32x16_bf16 v[80:95], v[100:103], v[108:111], v[80:95]
    ds_read_b64_tr_b16 v[124:125], v18 offset:28672
    ds_read_b64_tr_b16 v[126:127], v18 offset:29696
    s_waitcnt lgkmcnt(4)
    v_mfma_f32_32x32x16_bf16 v[32:47], v[112:115], v[120:123], v[32:47]
    s_waitcnt lgkmcnt(2)
    v_mfma_f32_32x32x16_bf16 v[48:63], v[116:119], v[120:123], v[48:63]
    s_waitcnt lgkmcnt(0)
    v_mfma_f32_32x32x16_bf16 v[64:79], v[112:115], v[124:127], v[64:79]
    v_mfma_f32_32x32x16_bf16 v[80:95], v[116:119], v[124:127], v[80:95]
    s_waitcnt vmcnt(0)
    v_mov_b32 v116, v200
    v_mov_b32 v117, v201
    v_mov_b32 v118, v202
    v_mov_b32 v119, v203
    s_mov_b32 s50, 0xc0135761
    s_mov_b32 s51, 0xc0135761
    s_mov_b32 s52, 0xbdd2d3e8
    s_mov_b32 s53, 0xbdd2d3e8
    s_mov_b32 s54, 1.0
    s_mov_b32 s55, 1.0
    s_lshl_b32 s56, s11, 4
    s_lshl_b32 s57, s14, 2
    s_add_u32 s56, s56, s57
    s_mul_i32 s56, s56, 33792
    s_lshl_b32 s57, s10, 11
    s_add_u32 s56, s56, s57
    v_lshlrev_b32 v28, 4, v15
    v_mul_u32_u24 v29, 33792, v7
    v_add_u32 v28, v28, v29
    s_waitcnt vmcnt(0)
    s_lshl_b32 s58, s46, 9
    s_add_u32 s58, s58, s56
    v_pk_fma_f32 v[32:33], v[160:161], v[116:117], v[32:33] op_sel_hi:[1,0,1]
    v_pk_fma_f32 v[48:49], v[176:177], v[116:117], v[48:49] op_sel_hi:[1,0,1]
    v_pk_mul_f32 v[32:33], v[32:33], v[116:117] op_sel:[0,1] op_sel_hi:[1,1]
    v_pk_mul_f32 v[48:49], v[48:49], v[116:117] op_sel:[0,1] op_sel_hi:[1,1]
    v_pk_mul_f32 v[120:121], v[32:33], v[32:33]
    v_pk_mul_f32 v[120:121], v[120:121], s[52:53]
    v_pk_add_f32 v[120:121], v[120:121], s[50:51]
    v_pk_mul_f32 v[120:121], v[120:121], v[32:33]
    v_exp_f32 v120, v120
    v_exp_f32 v121, v121
    v_pk_mul_f32 v[48:49], v[48:49], v[32:33]
    v_pk_add_f32 v[120:121], v[120:121], s[54:55]
    v_rcp_f32 v120, v120
    v_rcp_f32 v121, v121
    s_nop 0
    v_pk_mul_f32 v[48:49], v[48:49], v[120:121]
    v_cvt_pk_bf16_f32 v144, v48, v49
    v_pk_fma_f32 v[34:35], v[162:163], v[116:117], v[34:35] op_sel_hi:[1,0,1]
    v_pk_fma_f32 v[50:51], v[178:179], v[116:117], v[50:51] op_sel_hi:[1,0,1]
    v_pk_mul_f32 v[34:35], v[34:35], v[116:117] op_sel:[0,1] op_sel_hi:[1,1]
    v_pk_mul_f32 v[50:51], v[50:51], v[116:117] op_sel:[0,1] op_sel_hi:[1,1]
    v_pk_mul_f32 v[128:129], v[34:35], v[34:35]
    v_pk_mul_f32 v[128:129], v[128:129], s[52:53]
    v_pk_add_f32 v[128:129], v[128:129], s[50:51]
    v_pk_mul_f32 v[128:129], v[128:129], v[34:35]
    v_exp_f32 v128, v128
    v_exp_f32 v129, v129
    v_pk_mul_f32 v[50:51], v[50:51], v[34:35]
    v_pk_add_f32 v[128:129], v[128:129], s[54:55]
    v_rcp_f32 v128, v128
    v_rcp_f32 v129, v129
    s_nop 0
    v_pk_mul_f32 v[50:51], v[50:51], v[128:129]
    v_cvt_pk_bf16_f32 v145, v50, v51
    v_pk_fma_f32 v[36:37], v[164:165], v[116:117], v[36:37] op_sel_hi:[1,0,1]
    v_pk_fma_f32 v[52:53], v[180:181], v[116:117], v[52:53] op_sel_hi:[1,0,1]
    v_pk_mul_f32 v[36:37], v[36:37], v[116:117] op_sel:[0,1] op_sel_hi:[1,1]
    v_pk_mul_f32 v[52:53], v[52:53], v[116:117] op_sel:[0,1] op_sel_hi:[1,1]
    v_pk_mul_f32 v[120:121], v[36:37], v[36:37]
    v_pk_mul_f32 v[120:121], v[120:121], s[52:53]
    v_pk_add_f32 v[120:121], v[120:121], s[50:51]
    v_pk_mul_f32 v[120:121], v[120:121], v[36:37]
    v_exp_f32 v120, v120
    v_exp_f32 v121, v121
    v_pk_mul_f32 v[52:53], v[52:53], v[36:37]
    v_pk_add_f32 v[120:121], v[120:121], s[54:55]
    v_rcp_f32 v120, v120
    v_rcp_f32 v121, v121
    s_nop 0
    v_pk_mul_f32 v[52:53], v[52:53], v[120:121]
    v_cvt_pk_bf16_f32 v146, v52, v53
    v_pk_fma_f32 v[38:39], v[166:167], v[116:117], v[38:39] op_sel_hi:[1,0,1]
    v_pk_fma_f32 v[54:55], v[182:183], v[116:117], v[54:55] op_sel_hi:[1,0,1]
    v_pk_mul_f32 v[38:39], v[38:39], v[116:117] op_sel:[0,1] op_sel_hi:[1,1]
    v_pk_mul_f32 v[54:55], v[54:55], v[116:117] op_sel:[0,1] op_sel_hi:[1,1]
    v_pk_mul_f32 v[128:129], v[38:39], v[38:39]
    v_pk_mul_f32 v[128:129], v[128:129], s[52:53]
    v_pk_add_f32 v[128:129], v[128:129], s[50:51]
    v_pk_mul_f32 v[128:129], v[128:129], v[38:39]
    v_exp_f32 v128, v128
    v_exp_f32 v129, v129
    v_pk_mul_f32 v[54:55], v[54:55], v[38:39]
    v_pk_add_f32 v[128:129], v[128:129], s[54:55]
    v_rcp_f32 v128, v128
    v_rcp_f32 v129, v129
    s_nop 0
    v_pk_mul_f32 v[54:55], v[54:55], v[128:129]
    v_cvt_pk_bf16_f32 v147, v54, v55
    s_nop 1
    v_permlane32_swap_b32 v144, v146
    v_permlane32_swap_b32 v145, v147
    s_add_u32 s59, s58, 0
    s_nop 0
    buffer_store_dwordx4 v[144:147], v28, s[32:35], s59 offen sc1
    v_pk_fma_f32 v[40:41], v[168:169], v[116:117], v[40:41] op_sel_hi:[1,0,1]
    v_pk_fma_f32 v[56:57], v[184:185], v[116:117], v[56:57] op_sel_hi:[1,0,1]
    v_pk_mul_f32 v[40:41], v[40:41], v[116:117] op_sel:[0,1] op_sel_hi:[1,1]
    v_pk_mul_f32 v[56:57], v[56:57], v[116:117] op_sel:[0,1] op_sel_hi:[1,1]
    v_pk_mul_f32 v[120:121], v[40:41], v[40:41]
    v_pk_mul_f32 v[120:121], v[120:121], s[52:53]
    v_pk_add_f32 v[120:121], v[120:121], s[50:51]
    v_pk_mul_f32 v[120:121], v[120:121], v[40:41]
    v_exp_f32 v120, v120
    v_exp_f32 v121, v121
    v_pk_mul_f32 v[56:57], v[56:57], v[40:41]
    v_pk_add_f32 v[120:121], v[120:121], s[54:55]
    v_rcp_f32 v120, v120
    v_rcp_f32 v121, v121
    s_nop 0
    v_pk_mul_f32 v[56:57], v[56:57], v[120:121]
    v_cvt_pk_bf16_f32 v148, v56, v57
    v_pk_fma_f32 v[42:43], v[170:171], v[116:117], v[42:43] op_sel_hi:[1,0,1]
    v_pk_fma_f32 v[58:59], v[186:187], v[116:117], v[58:59] op_sel_hi:[1,0,1]
    v_pk_mul_f32 v[42:43], v[42:43], v[116:117] op_sel:[0,1] op_sel_hi:[1,1]
    v_pk_mul_f32 v[58:59], v[58:59], v[116:117] op_sel:[0,1] op_sel_hi:[1,1]
    v_pk_mul_f32 v[128:129], v[42:43], v[42:43]
    v_pk_mul_f32 v[128:129], v[128:129], s[52:53]
    v_pk_add_f32 v[128:129], v[128:129], s[50:51]
    v_pk_mul_f32 v[128:129], v[128:129], v[42:43]
    v_exp_f32 v128, v128
    v_exp_f32 v129, v129
    v_pk_mul_f32 v[58:59], v[58:59], v[42:43]
    v_pk_add_f32 v[128:129], v[128:129], s[54:55]
    v_rcp_f32 v128, v128
    v_rcp_f32 v129, v129
    s_nop 0
    v_pk_mul_f32 v[58:59], v[58:59], v[128:129]
    v_cvt_pk_bf16_f32 v149, v58, v59
    v_pk_fma_f32 v[44:45], v[172:173], v[116:117], v[44:45] op_sel_hi:[1,0,1]
    v_pk_fma_f32 v[60:61], v[188:189], v[116:117], v[60:61] op_sel_hi:[1,0,1]
    v_pk_mul_f32 v[44:45], v[44:45], v[116:117] op_sel:[0,1] op_sel_hi:[1,1]
    v_pk_mul_f32 v[60:61], v[60:61], v[116:117] op_sel:[0,1] op_sel_hi:[1,1]
    v_pk_mul_f32 v[120:121], v[44:45], v[44:45]
    v_pk_mul_f32 v[120:121], v[120:121], s[52:53]
    v_pk_add_f32 v[120:121], v[120:121], s[50:51]
    v_pk_mul_f32 v[120:121], v[120:121], v[44:45]
    v_exp_f32 v120, v120
    v_exp_f32 v121, v121
    v_pk_mul_f32 v[60:61], v[60:61], v[44:45]
    v_pk_add_f32 v[120:121], v[120:121], s[54:55]
    v_rcp_f32 v120, v120
    v_rcp_f32 v121, v121
    s_nop 0
    v_pk_mul_f32 v[60:61], v[60:61], v[120:121]
    v_cvt_pk_bf16_f32 v150, v60, v61
    v_pk_fma_f32 v[46:47], v[174:175], v[116:117], v[46:47] op_sel_hi:[1,0,1]
    v_pk_fma_f32 v[62:63], v[190:191], v[116:117], v[62:63] op_sel_hi:[1,0,1]
    v_pk_mul_f32 v[46:47], v[46:47], v[116:117] op_sel:[0,1] op_sel_hi:[1,1]
    v_pk_mul_f32 v[62:63], v[62:63], v[116:117] op_sel:[0,1] op_sel_hi:[1,1]
    v_pk_mul_f32 v[128:129], v[46:47], v[46:47]
    v_pk_mul_f32 v[128:129], v[128:129], s[52:53]
    v_pk_add_f32 v[128:129], v[128:129], s[50:51]
    v_pk_mul_f32 v[128:129], v[128:129], v[46:47]
    v_exp_f32 v128, v128
    v_exp_f32 v129, v129
    v_pk_mul_f32 v[62:63], v[62:63], v[46:47]
    v_pk_add_f32 v[128:129], v[128:129], s[54:55]
    v_rcp_f32 v128, v128
    v_rcp_f32 v129, v129
    s_nop 0
    v_pk_mul_f32 v[62:63], v[62:63], v[128:129]
    v_cvt_pk_bf16_f32 v151, v62, v63
    s_nop 1
    v_permlane32_swap_b32 v148, v150
    v_permlane32_swap_b32 v149, v151
    s_add_u32 s59, s58, 67584
    s_nop 0
    buffer_store_dwordx4 v[148:151], v28, s[32:35], s59 offen sc1
    s_lshl_b32 s58, s47, 9
    s_add_u32 s58, s58, s56
    v_pk_fma_f32 v[64:65], v[160:161], v[118:119], v[64:65] op_sel_hi:[1,0,1]
    v_pk_fma_f32 v[80:81], v[176:177], v[118:119], v[80:81] op_sel_hi:[1,0,1]
    v_pk_mul_f32 v[64:65], v[64:65], v[118:119] op_sel:[0,1] op_sel_hi:[1,1]
    v_pk_mul_f32 v[80:81], v[80:81], v[118:119] op_sel:[0,1] op_sel_hi:[1,1]
    v_pk_mul_f32 v[120:121], v[64:65], v[64:65]
    v_pk_mul_f32 v[120:121], v[120:121], s[52:53]
    v_pk_add_f32 v[120:121], v[120:121], s[50:51]
    v_pk_mul_f32 v[120:121], v[120:121], v[64:65]
    v_exp_f32 v120, v120
    v_exp_f32 v121, v121
    v_pk_mul_f32 v[80:81], v[80:81], v[64:65]
    v_pk_add_f32 v[120:121], v[120:121], s[54:55]
    v_rcp_f32 v120, v120
    v_rcp_f32 v121, v121
    s_nop 0
    v_pk_mul_f32 v[80:81], v[80:81], v[120:121]
    v_cvt_pk_bf16_f32 v152, v80, v81
    v_pk_fma_f32 v[66:67], v[162:163], v[118:119], v[66:67] op_sel_hi:[1,0,1]
    v_pk_fma_f32 v[82:83], v[178:179], v[118:119], v[82:83] op_sel_hi:[1,0,1]
    v_pk_mul_f32 v[66:67], v[66:67], v[118:119] op_sel:[0,1] op_sel_hi:[1,1]
    v_pk_mul_f32 v[82:83], v[82:83], v[118:119] op_sel:[0,1] op_sel_hi:[1,1]
    v_pk_mul_f32 v[128:129], v[66:67], v[66:67]
    v_pk_mul_f32 v[128:129], v[128:129], s[52:53]
    v_pk_add_f32 v[128:129], v[128:129], s[50:51]
    v_pk_mul_f32 v[128:129], v[128:129], v[66:67]
    v_exp_f32 v128, v128
    v_exp_f32 v129, v129
    v_pk_mul_f32 v[82:83], v[82:83], v[66:67]
    v_pk_add_f32 v[128:129], v[128:129], s[54:55]
    v_rcp_f32 v128, v128
    v_rcp_f32 v129, v129
    s_nop 0
    v_pk_mul_f32 v[82:83], v[82:83], v[128:129]
    v_cvt_pk_bf16_f32 v153, v82, v83
    v_pk_fma_f32 v[68:69], v[164:165], v[118:119], v[68:69] op_sel_hi:[1,0,1]
    v_pk_fma_f32 v[84:85], v[180:181], v[118:119], v[84:85] op_sel_hi:[1,0,1]
    v_pk_mul_f32 v[68:69], v[68:69], v[118:119] op_sel:[0,1] op_sel_hi:[1,1]
    v_pk_mul_f32 v[84:85], v[84:85], v[118:119] op_sel:[0,1] op_sel_hi:[1,1]
    v_pk_mul_f32 v[120:121], v[68:69], v[68:69]
    v_pk_mul_f32 v[120:121], v[120:121], s[52:53]
    v_pk_add_f32 v[120:121], v[120:121], s[50:51]
    v_pk_mul_f32 v[120:121], v[120:121], v[68:69]
    v_exp_f32 v120, v120
    v_exp_f32 v121, v121
    v_pk_mul_f32 v[84:85], v[84:85], v[68:69]
    v_pk_add_f32 v[120:121], v[120:121], s[54:55]
    v_rcp_f32 v120, v120
    v_rcp_f32 v121, v121
    s_nop 0
    v_pk_mul_f32 v[84:85], v[84:85], v[120:121]
    v_cvt_pk_bf16_f32 v154, v84, v85
    v_pk_fma_f32 v[70:71], v[166:167], v[118:119], v[70:71] op_sel_hi:[1,0,1]
    v_pk_fma_f32 v[86:87], v[182:183], v[118:119], v[86:87] op_sel_hi:[1,0,1]
    v_pk_mul_f32 v[70:71], v[70:71], v[118:119] op_sel:[0,1] op_sel_hi:[1,1]
    v_pk_mul_f32 v[86:87], v[86:87], v[118:119] op_sel:[0,1] op_sel_hi:[1,1]
    v_pk_mul_f32 v[128:129], v[70:71], v[70:71]
    v_pk_mul_f32 v[128:129], v[128:129], s[52:53]
    v_pk_add_f32 v[128:129], v[128:129], s[50:51]
    v_pk_mul_f32 v[128:129], v[128:129], v[70:71]
    v_exp_f32 v128, v128
    v_exp_f32 v129, v129
    v_pk_mul_f32 v[86:87], v[86:87], v[70:71]
    v_pk_add_f32 v[128:129], v[128:129], s[54:55]
    v_rcp_f32 v128, v128
    v_rcp_f32 v129, v129
    s_nop 0
    v_pk_mul_f32 v[86:87], v[86:87], v[128:129]
    v_cvt_pk_bf16_f32 v155, v86, v87
    s_nop 1
    v_permlane32_swap_b32 v152, v154
    v_permlane32_swap_b32 v153, v155
    s_add_u32 s59, s58, 0
    s_nop 0
    buffer_store_dwordx4 v[152:155], v28, s[32:35], s59 offen sc1
    v_pk_fma_f32 v[72:73], v[168:169], v[118:119], v[72:73] op_sel_hi:[1,0,1]
    v_pk_fma_f32 v[88:89], v[184:185], v[118:119], v[88:89] op_sel_hi:[1,0,1]
    v_pk_mul_f32 v[72:73], v[72:73], v[118:119] op_sel:[0,1] op_sel_hi:[1,1]
    v_pk_mul_f32 v[88:89], v[88:89], v[118:119] op_sel:[0,1] op_sel_hi:[1,1]
    v_pk_mul_f32 v[120:121], v[72:73], v[72:73]
    v_pk_mul_f32 v[120:121], v[120:121], s[52:53]
    v_pk_add_f32 v[120:121], v[120:121], s[50:51]
    v_pk_mul_f32 v[120:121], v[120:121], v[72:73]
    v_exp_f32 v120, v120
    v_exp_f32 v121, v121
    v_pk_mul_f32 v[88:89], v[88:89], v[72:73]
    v_pk_add_f32 v[120:121], v[120:121], s[54:55]
    v_rcp_f32 v120, v120
    v_rcp_f32 v121, v121
    s_nop 0
    v_pk_mul_f32 v[88:89], v[88:89], v[120:121]
    v_cvt_pk_bf16_f32 v156, v88, v89
    v_pk_fma_f32 v[74:75], v[170:171], v[118:119], v[74:75] op_sel_hi:[1,0,1]
    v_pk_fma_f32 v[90:91], v[186:187], v[118:119], v[90:91] op_sel_hi:[1,0,1]
    v_pk_mul_f32 v[74:75], v[74:75], v[118:119] op_sel:[0,1] op_sel_hi:[1,1]
    v_pk_mul_f32 v[90:91], v[90:91], v[118:119] op_sel:[0,1] op_sel_hi:[1,1]
    v_pk_mul_f32 v[128:129], v[74:75], v[74:75]
    v_pk_mul_f32 v[128:129], v[128:129], s[52:53]
    v_pk_add_f32 v[128:129], v[128:129], s[50:51]
    v_pk_mul_f32 v[128:129], v[128:129], v[74:75]
    v_exp_f32 v128, v128
    v_exp_f32 v129, v129
    v_pk_mul_f32 v[90:91], v[90:91], v[74:75]
    v_pk_add_f32 v[128:129], v[128:129], s[54:55]
    v_rcp_f32 v128, v128
    v_rcp_f32 v129, v129
    s_nop 0
    v_pk_mul_f32 v[90:91], v[90:91], v[128:129]
    v_cvt_pk_bf16_f32 v157, v90, v91
    v_pk_fma_f32 v[76:77], v[172:173], v[118:119], v[76:77] op_sel_hi:[1,0,1]
    v_pk_fma_f32 v[92:93], v[188:189], v[118:119], v[92:93] op_sel_hi:[1,0,1]
    v_pk_mul_f32 v[76:77], v[76:77], v[118:119] op_sel:[0,1] op_sel_hi:[1,1]
    v_pk_mul_f32 v[92:93], v[92:93], v[118:119] op_sel:[0,1] op_sel_hi:[1,1]
    v_pk_mul_f32 v[120:121], v[76:77], v[76:77]
    v_pk_mul_f32 v[120:121], v[120:121], s[52:53]
    v_pk_add_f32 v[120:121], v[120:121], s[50:51]
    v_pk_mul_f32 v[120:121], v[120:121], v[76:77]
    v_exp_f32 v120, v120
    v_exp_f32 v121, v121
    v_pk_mul_f32 v[92:93], v[92:93], v[76:77]
    v_pk_add_f32 v[120:121], v[120:121], s[54:55]
    v_rcp_f32 v120, v120
    v_rcp_f32 v121, v121
    s_nop 0
    v_pk_mul_f32 v[92:93], v[92:93], v[120:121]
    v_cvt_pk_bf16_f32 v158, v92, v93
    v_pk_fma_f32 v[78:79], v[174:175], v[118:119], v[78:79] op_sel_hi:[1,0,1]
    v_pk_fma_f32 v[94:95], v[190:191], v[118:119], v[94:95] op_sel_hi:[1,0,1]
    v_pk_mul_f32 v[78:79], v[78:79], v[118:119] op_sel:[0,1] op_sel_hi:[1,1]
    v_pk_mul_f32 v[94:95], v[94:95], v[118:119] op_sel:[0,1] op_sel_hi:[1,1]
    v_pk_mul_f32 v[128:129], v[78:79], v[78:79]
    v_pk_mul_f32 v[128:129], v[128:129], s[52:53]
    v_pk_add_f32 v[128:129], v[128:129], s[50:51]
    v_pk_mul_f32 v[128:129], v[128:129], v[78:79]
    v_exp_f32 v128, v128
    v_exp_f32 v129, v129
    v_pk_mul_f32 v[94:95], v[94:95], v[78:79]
    v_pk_add_f32 v[128:129], v[128:129], s[54:55]
    v_rcp_f32 v128, v128
    v_rcp_f32 v129, v129
    s_nop 0
    v_pk_mul_f32 v[94:95], v[94:95], v[128:129]
    v_cvt_pk_bf16_f32 v159, v94, v95
    s_nop 1
    v_permlane32_swap_b32 v156, v158
    v_permlane32_swap_b32 v157, v159
    s_add_u32 s59, s58, 67584
    s_nop 0
    buffer_store_dwordx4 v[156:159], v28, s[32:35], s59 offen sc1
K3_END:
    s_endpgm
K3_STAT:
    s_load_dwordx2 s[8:9], s[0:1], 120
    s_load_dwordx2 s[60:61], s[0:1], 112
    s_mov_b32 s10, s2
    v_lshrrev_b32 v1, 6, v0
    v_and_b32 v2, 63, v0
    v_lshrrev_b32 v3, 4, v0
    v_and_b32 v4, 15, v0
    v_readfirstlane_b32 s3, v1
    v_mul_u32_u24 v5, 60928, v3
    v_lshl_add_u32 v5, v4, 4, v5
    s_lshl_b32 s36, s10, 8
    s_waitcnt lgkmcnt(0)
    s_add_u32 s24, s8, 5963776
    s_addc_u32 s25, s9, 0
    s_mov_b32 s26, 1949696
    s_mov_b32 s27, 0x00020000
    s_add_u32 s64, s8, 7929856
    s_addc_u32 s65, s9, 0
    s_mov_b32 s66, 16384
    s_mov_b32 s67, 0x00020000
    buffer_load_dwordx4 v[32:35], v5, s[24:27], s36 offen
    s_add_u32 s36, s36, 4352
    buffer_load_dwordx4 v[36:39], v5, s[24:27], s36 offen
    s_add_u32 s36, s36, 4352
    buffer_load_dwordx4 v[40:43], v5, s[24:27], s36 offen
    s_add_u32 s36, s36, 4352
    buffer_load_dwordx4 v[44:47], v5, s[24:27], s36 offen
    s_add_u32 s36, s36, 4352
    buffer_load_dwordx4 v[48:51], v5, s[24:27], s36 offen
    s_add_u32 s36, s36, 4352
    buffer_load_dwordx4 v[52:55], v5, s[24:27], s36 offen
    s_add_u32 s36, s36, 4352
    buffer_load_dwordx4 v[56:59], v5, s[24:27], s36 offen
    s_add_u32 s36, s36, 4352
    buffer_load_dwordx4 v[60:63], v5, s[24:27], s36 offen
    s_add_u32 s36, s36, 4352
    buffer_load_dwordx4 v[64:67], v5, s[24:27], s36 offen
    s_add_u32 s36, s36, 4352
    buffer_load_dwordx4 v[68:71], v5, s[24:27], s36 offen
    s_add_u32 s36, s36, 4352
    buffer_load_dwordx4 v[72:75], v5, s[24:27], s36 offen
    s_add_u32 s36, s36, 4352
    buffer_load_dwordx4 v[76:79], v5, s[24:27], s36 offen
    s_add_u32 s36, s36, 4352
    buffer_load_dwordx4 v[80:83], v5, s[24:27], s36 offen
    s_add_u32 s36, s36, 4352
    buffer_load_dwordx4 v[84:87], v5, s[24:27], s36 offen
    s_add_u32 s36, s36, 4352
    v_mov_b32 v96, 0
    v_mov_b32 v97, 0
    v_mov_b32 v98, 0
    v_mov_b32 v99, 0
    v_mov_b32 v100, 0
    v_mov_b32 v101, 0
    v_mov_b32 v102, 0
    v_mov_b32 v103, 0
    v_mov_b32 v104, 0
    v_mov_b32 v105, 0
    v_mov_b32 v106, 0
    v_mov_b32 v107, 0
    v_mov_b32 v108, 0
    v_mov_b32 v109, 0
    v_mov_b32 v110, 0
    v_mov_b32 v111, 0
    s_waitcnt vmcnt(13)
    v_lshlrev_b32 v112, 16, v32
    v_and_b32 v113, 0xffff0000, v32
    v_lshlrev_b32 v114, 16, v33
    v_and_b32 v115, 0xffff0000, v33
    v_lshlrev_b32 v116, 16, v34
    v_and_b32 v117, 0xffff0000, v34
    v_lshlrev_b32 v118, 16, v35
    v_and_b32 v119, 0xffff0000, v35
    v_add_f32 v96, v96, v112
    v_fmac_f32 v104, v112, v112
    v_add_f32 v97, v97, v113
    v_fmac_f32 v105, v113, v113
    v_add_f32 v98, v98, v114
    v_fmac_f32 v106, v114, v114
    v_add_f32 v99, v99, v115
    v_fmac_f32 v107, v115, v115
    v_add_f32 v100, v100, v116
    v_fmac_f32 v108, v116, v116
    v_add_f32 v101, v101, v117
    v_fmac_f32 v109, v117, v117
    v_add_f32 v102, v102, v118
    v_fmac_f32 v110, v118, v118
    v_add_f32 v103, v103, v119
    v_fmac_f32 v111, v119, v119
    s_waitcnt vmcnt(12)
    v_lshlrev_b32 v112, 16, v36
    v_and_b32 v113, 0xffff0000, v36
    v_lshlrev_b32 v114, 16, v37
    v_and_b32 v115, 0xffff0000, v37
    v_lshlrev_b32 v116, 16, v38
    v_and_b32 v117, 0xffff0000, v38
    v_lshlrev_b32 v118, 16, v39
    v_and_b32 v119, 0xffff0000, v39
    v_add_f32 v96, v96, v112
    v_fmac_f32 v104, v112, v112
    v_add_f32 v97, v97, v113
    v_fmac_f32 v105, v113, v113
    v_add_f32 v98, v98, v114
    v_fmac_f32 v106, v114, v114
    v_add_f32 v99, v99, v115
    v_fmac_f32 v107, v115, v115
    v_add_f32 v100, v100, v116
    v_fmac_f32 v108, v116, v116
    v_add_f32 v101, v101, v117
    v_fmac_f32 v109, v117, v117
    v_add_f32 v102, v102, v118
    v_fmac_f32 v110, v118, v118
    v_add_f32 v103, v103, v119
    v_fmac_f32 v111, v119, v119
    s_waitcnt vmcnt(11)
    v_lshlrev_b32 v112, 16, v40
    v_and_b32 v113, 0xffff0000, v40
    v_lshlrev_b32 v114, 16, v41
    v_and_b32 v115, 0xffff0000, v41
    v_lshlrev_b32 v116, 16, v42
    v_and_b32 v117, 0xffff0000, v42
    v_lshlrev_b32 v118, 16, v43
    v_and_b32 v119, 0xffff0000, v43
    v_add_f32 v96, v96, v112
    v_fmac_f32 v104, v112, v112
    v_add_f32 v97, v97, v113
    v_fmac_f32 v105, v113, v113
    v_add_f32 v98, v98, v114
    v_fmac_f32 v106, v114, v114
    v_add_f32 v99, v99, v115
    v_fmac_f32 v107, v115, v115
    v_add_f32 v100, v100, v116
    v_fmac_f32 v108, v116, v116
    v_add_f32 v101, v101, v117
    v_fmac_f32 v109, v117, v117
    v_add_f32 v102, v102, v118
    v_fmac_f32 v110, v118, v118
    v_add_f32 v103, v103, v119
    v_fmac_f32 v111, v119, v119
    s_waitcnt vmcnt(10)
    v_lshlrev_b32 v112, 16, v44
    v_and_b32 v113, 0xffff0000, v44
    v_lshlrev_b32 v114, 16, v45
    v_and_b32 v115, 0xffff0000, v45
    v_lshlrev_b32 v116, 16, v46
    v_and_b32 v117, 0xffff0000, v46
    v_lshlrev_b32 v118, 16, v47
    v_and_b32 v119, 0xffff0000, v47
    v_add_f32 v96, v96, v112
    v_fmac_f32 v104, v112, v112
    v_add_f32 v97, v97, v113
    v_fmac_f32 v105, v113, v113
    v_add_f32 v98, v98, v114
    v_fmac_f32 v106, v114, v114
    v_add_f32 v99, v99, v115
    v_fmac_f32 v107, v115, v115
    v_add_f32 v100, v100, v116
    v_fmac_f32 v108, v116, v116
    v_add_f32 v101, v101, v117
    v_fmac_f32 v109, v117, v117
    v_add_f32 v102, v102, v118
    v_fmac_f32 v110, v118, v118
    v_add_f32 v103, v103, v119
    v_fmac_f32 v111, v119, v119
    s_waitcnt vmcnt(9)
    v_lshlrev_b32 v112, 16, v48
    v_and_b32 v113, 0xffff0000, v48
    v_lshlrev_b32 v114, 16, v49
    v_and_b32 v115, 0xffff0000, v49
    v_lshlrev_b32 v116, 16, v50
    v_and_b32 v117, 0xffff0000, v50
    v_lshlrev_b32 v118, 16, v51
    v_and_b32 v119, 0xffff0000, v51
    v_add_f32 v96, v96, v112
    v_fmac_f32 v104, v112, v112
    v_add_f32 v97, v97, v113
    v_fmac_f32 v105, v113, v113
    v_add_f32 v98, v98, v114
    v_fmac_f32 v106, v114, v114
    v_add_f32 v99, v99, v115
    v_fmac_f32 v107, v115, v115
    v_add_f32 v100, v100, v116
    v_fmac_f32 v108, v116, v116
    v_add_f32 v101, v101, v117
    v_fmac_f32 v109, v117, v117
    v_add_f32 v102, v102, v118
    v_fmac_f32 v110, v118, v118
    v_add_f32 v103, v103, v119
    v_fmac_f32 v111, v119, v119
    s_waitcnt vmcnt(8)
    v_lshlrev_b32 v112, 16, v52
    v_and_b32 v113, 0xffff0000, v52
    v_lshlrev_b32 v114, 16, v53
    v_and_b32 v115, 0xffff0000, v53
    v_lshlrev_b32 v116, 16, v54
    v_and_b32 v117, 0xffff0000, v54
    v_lshlrev_b32 v118, 16, v55
    v_and_b32 v119, 0xffff0000, v55
    v_add_f32 v96, v96, v112
    v_fmac_f32 v104, v112, v112
    v_add_f32 v97, v97, v113
    v_fmac_f32 v105, v113, v113
    v_add_f32 v98, v98, v114
    v_fmac_f32 v106, v114, v114
    v_add_f32 v99, v99, v115
    v_fmac_f32 v107, v115, v115
    v_add_f32 v100, v100, v116
    v_fmac_f32 v108, v116, v116
    v_add_f32 v101, v101, v117
    v_fmac_f32 v109, v117, v117
    v_add_f32 v102, v102, v118
    v_fmac_f32 v110, v118, v118
    v_add_f32 v103, v103, v119
    v_fmac_f32 v111, v119, v119
    s_waitcnt vmcnt(7)
    v_lshlrev_b32 v112, 16, v56
    v_and_b32 v113, 0xffff0000, v56
    v_lshlrev_b32 v114, 16, v57
    v_and_b32 v115, 0xffff0000, v57
    v_lshlrev_b32 v116, 16, v58
    v_and_b32 v117, 0xffff0000, v58
    v_lshlrev_b32 v118, 16, v59
    v_and_b32 v119, 0xffff0000, v59
    v_add_f32 v96, v96, v112
    v_fmac_f32 v104, v112, v112
    v_add_f32 v97, v97, v113
    v_fmac_f32 v105, v113, v113
    v_add_f32 v98, v98, v114
    v_fmac_f32 v106, v114, v114
    v_add_f32 v99, v99, v115
    v_fmac_f32 v107, v115, v115
    v_add_f32 v100, v100, v116
    v_fmac_f32 v108, v116, v116
    v_add_f32 v101, v101, v117
    v_fmac_f32 v109, v117, v117
    v_add_f32 v102, v102, v118
    v_fmac_f32 v110, v118, v118
    v_add_f32 v103, v103, v119
    v_fmac_f32 v111, v119, v119
    s_waitcnt vmcnt(6)
    v_lshlrev_b32 v112, 16, v60
    v_and_b32 v113, 0xffff0000, v60
    v_lshlrev_b32 v114, 16, v61
    v_and_b32 v115, 0xffff0000, v61
    v_lshlrev_b32 v116, 16, v62
    v_and_b32 v117, 0xffff0000, v62
    v_lshlrev_b32 v118, 16, v63
    v_and_b32 v119, 0xffff0000, v63
    v_add_f32 v96, v96, v112
    v_fmac_f32 v104, v112, v112
    v_add_f32 v97, v97, v113
    v_fmac_f32 v105, v113, v113
    v_add_f32 v98, v98, v114
    v_fmac_f32 v106, v114, v114
    v_add_f32 v99, v99, v115
    v_fmac_f32 v107, v115, v115
    v_add_f32 v100, v100, v116
    v_fmac_f32 v108, v116, v116
    v_add_f32 v101, v101, v117
    v_fmac_f32 v109, v117, v117
    v_add_f32 v102, v102, v118
    v_fmac_f32 v110, v118, v118
    v_add_f32 v103, v103, v119
    v_fmac_f32 v111, v119, v119
    s_waitcnt vmcnt(5)
    v_lshlrev_b32 v112, 16, v64
    v_and_b32 v113, 0xffff0000, v64
    v_lshlrev_b32 v114, 16, v65
    v_and_b32 v115, 0xffff0000, v65
    v_lshlrev_b32 v116, 16, v66
    v_and_b32 v117, 0xffff0000, v66
    v_lshlrev_b32 v118, 16, v67
    v_and_b32 v119, 0xffff0000, v67
    v_add_f32 v96, v96, v112
    v_fmac_f32 v104, v112, v112
    v_add_f32 v97, v97, v113
    v_fmac_f32 v105, v113, v113
    v_add_f32 v98, v98, v114
    v_fmac_f32 v106, v114, v114
    v_add_f32 v99, v99, v115
    v_fmac_f32 v107, v115, v115
    v_add_f32 v100, v100, v116
    v_fmac_f32 v108, v116, v116
    v_add_f32 v101, v101, v117
    v_fmac_f32 v109, v117, v117
    v_add_f32 v102, v102, v118
    v_fmac_f32 v110, v118, v118
    v_add_f32 v103, v103, v119
    v_fmac_f32 v111, v119, v119
    s_waitcnt vmcnt(4)
    v_lshlrev_b32 v112, 16, v68
    v_and_b32 v113, 0xffff0000, v68
    v_lshlrev_b32 v114, 16, v69
    v_and_b32 v115, 0xffff0000, v69
    v_lshlrev_b32 v116, 16, v70
    v_and_b32 v117, 0xffff0000, v70
    v_lshlrev_b32 v118, 16, v71
    v_and_b32 v119, 0xffff0000, v71
    v_add_f32 v96, v96, v112
    v_fmac_f32 v104, v112, v112
    v_add_f32 v97, v97, v113
    v_fmac_f32 v105, v113, v113
    v_add_f32 v98, v98, v114
    v_fmac_f32 v106, v114, v114
    v_add_f32 v99, v99, v115
    v_fmac_f32 v107, v115, v115
    v_add_f32 v100, v100, v116
    v_fmac_f32 v108, v116, v116
    v_add_f32 v101, v101, v117
    v_fmac_f32 v109, v117, v117
    v_add_f32 v102, v102, v118
    v_fmac_f32 v110, v118, v118
    v_add_f32 v103, v103, v119
    v_fmac_f32 v111, v119, v119
    s_waitcnt vmcnt(3)
    v_lshlrev_b32 v112, 16, v72
    v_and_b32 v113, 0xffff0000, v72
    v_lshlrev_b32 v114, 16, v73
    v_and_b32 v115, 0xffff0000, v73
    v_lshlrev_b32 v116, 16, v74
    v_and_b32 v117, 0xffff0000, v74
    v_lshlrev_b32 v118, 16, v75
    v_and_b32 v119, 0xffff0000, v75
    v_add_f32 v96, v96, v112
    v_fmac_f32 v104, v112, v112
    v_add_f32 v97, v97, v113
    v_fmac_f32 v105, v113, v113
    v_add_f32 v98, v98, v114
    v_fmac_f32 v106, v114, v114
    v_add_f32 v99, v99, v115
    v_fmac_f32 v107, v115, v115
    v_add_f32 v100, v100, v116
    v_fmac_f32 v108, v116, v116
    v_add_f32 v101, v101, v117
    v_fmac_f32 v109, v117, v117
    v_add_f32 v102, v102, v118
    v_fmac_f32 v110, v118, v118
    v_add_f32 v103, v103, v119
    v_fmac_f32 v111, v119, v119
    s_waitcnt vmcnt(2)
    v_lshlrev_b32 v112, 16, v76
    v_and_b32 v113, 0xffff0000, v76
    v_lshlrev_b32 v114, 16, v77
    v_and_b32 v115, 0xffff0000, v77
    v_lshlrev_b32 v116, 16, v78
    v_and_b32 v117, 0xffff0000, v78
    v_lshlrev_b32 v118, 16, v79
    v_and_b32 v119, 0xffff0000, v79
    v_add_f32 v96, v96, v112
    v_fmac_f32 v104, v112, v112
    v_add_f32 v97, v97, v113
    v_fmac_f32 v105, v113, v113
    v_add_f32 v98, v98, v114
    v_fmac_f32 v106, v114, v114
    v_add_f32 v99, v99, v115
    v_fmac_f32 v107, v115, v115
    v_add_f32 v100, v100, v116
    v_fmac_f32 v108, v116, v116
    v_add_f32 v101, v101, v117
    v_fmac_f32 v109, v117, v117
    v_add_f32 v102, v102, v118
    v_fmac_f32 v110, v118, v118
    v_add_f32 v103, v103, v119
    v_fmac_f32 v111, v119, v119
    s_waitcnt vmcnt(1)
    v_lshlrev_b32 v112, 16, v80
    v_and_b32 v113, 0xffff0000, v80
    v_lshlrev_b32 v114, 16, v81
    v_and_b32 v115, 0xffff0000, v81
    v_lshlrev_b32 v116, 16, v82
    v_and_b32 v117, 0xffff0000, v82
    v_lshlrev_b32 v118, 16, v83
    v_and_b32 v119, 0xffff0000, v83
    v_add_f32 v96, v96, v112
    v_fmac_f32 v104, v112, v112
    v_add_f32 v97, v97, v113
    v_fmac_f32 v105, v113, v113
    v_add_f32 v98, v98, v114
    v_fmac_f32 v106, v114, v114
    v_add_f32 v99, v99, v115
    v_fmac_f32 v107, v115, v115
    v_add_f32 v100, v100, v116
    v_fmac_f32 v108, v116, v116
    v_add_f32 v101, v101, v117
    v_fmac_f32 v109, v117, v117
    v_add_f32 v102, v102, v118
    v_fmac_f32 v110, v118, v118
    v_add_f32 v103, v103, v119
    v_fmac_f32 v111, v119, v119
    s_waitcnt vmcnt(0)
    v_lshlrev_b32 v112, 16, v84
    v_and_b32 v113, 0xffff0000, v84
    v_lshlrev_b32 v114, 16, v85
    v_and_b32 v115, 0xffff0000, v85
    v_lshlrev_b32 v116, 16, v86
    v_and_b32 v117, 0xffff0000, v86
    v_lshlrev_b32 v118, 16, v87
    v_and_b32 v119, 0xffff0000, v87
    v_add_f32 v96, v96, v112
    v_fmac_f32 v104, v112, v112
    v_add_f32 v97, v97, v113
    v_fmac_f32 v105, v113, v113
    v_add_f32 v98, v98, v114
    v_fmac_f32 v106, v114, v114
    v_add_f32 v99, v99, v115
    v_fmac_f32 v107, v115, v115
    v_add_f32 v100, v100, v116
    v_fmac_f32 v108, v116, v116
    v_add_f32 v101, v101, v117
    v_fmac_f32 v109, v117, v117
    v_add_f32 v102, v102, v118
    v_fmac_f32 v110, v118, v118
    v_add_f32 v103, v103, v119
    v_fmac_f32 v111, v119, v119
    s_nop 1
    v_permlane32_swap_b32 v96, v104
    v_permlane32_swap_b32 v97, v105
    v_permlane32_swap_b32 v98, v106
    v_permlane32_swap_b32 v99, v107
    v_permlane32_swap_b32 v100, v108
    v_permlane32_swap_b32 v101, v109
    v_permlane32_swap_b32 v102, v110
    v_permlane32_swap_b32 v103, v111
    s_nop 1
    v_add_f32 v96, v96, v104
    v_add_f32 v97, v97, v105
    v_add_f32 v98, v98, v106
    v_add_f32 v99, v99, v107
    v_add_f32 v100, v100, v108
    v_add_f32 v101, v101, v109
    v_add_f32 v102, v102, v110
    v_add_f32 v103, v103, v111
    s_nop 1
    v_permlane16_swap_b32 v96, v100
    v_permlane16_swap_b32 v97, v101
    v_permlane16_swap_b32 v98, v102
    v_permlane16_swap_b32 v99, v103
    s_nop 1
    v_add_f32 v96, v96, v100
    v_add_f32 v97, v97, v101
    v_add_f32 v98, v98, v102
    v_add_f32 v99, v99, v103
    v_lshrrev_b32 v11, 4, v2
    v_lshlrev_b32 v10, 5, v4
    v_and_b32 v12, 1, v11
    v_lshl_add_u32 v10, v12, 4, v10
    v_lshrrev_b32 v11, 1, v11
    v_lshl_add_u32 v10, v11, 9, v10
    s_lshl_b32 s40, s3, 10
    v_add_u32 v10, s40, v10
    ds_write_b128 v10, v[96:99]
    s_waitcnt lgkmcnt(0)
    s_barrier
    s_cmp_lt_u32 s3, 2
    s_cbranch_scc0 K3_ST2
    v_lshlrev_b32 v10, 2, v0
    ds_read_b32 v32, v10 offset:0
    ds_read_b32 v33, v10 offset:512
    ds_read_b32 v34, v10 offset:1024
    ds_read_b32 v35, v10 offset:1536
    ds_read_b32 v36, v10 offset:2048
    ds_read_b32 v37, v10 offset:2560
    ds_read_b32 v38, v10 offset:3072
    ds_read_b32 v39, v10 offset:3584
    ds_read_b32 v40, v10 offset:4096
    ds_read_b32 v41, v10 offset:4608
    ds_read_b32 v42, v10 offset:5120
    ds_read_b32 v43, v10 offset:5632
    ds_read_b32 v44, v10 offset:6144
    ds_read_b32 v45, v10 offset:6656
    ds_read_b32 v46, v10 offset:7168
    ds_read_b32 v47, v10 offset:7680
    s_waitcnt lgkmcnt(0)
    v_pk_add_f32 v[32:33], v[32:33], v[40:41]
    v_pk_add_f32 v[34:35], v[34:35], v[42:43]
    v_pk_add_f32 v[36:37], v[36:37], v[44:45]
    v_pk_add_f32 v[38:39], v[38:39], v[46:47]
    v_pk_add_f32 v[32:33], v[32:33], v[36:37]
    v_pk_add_f32 v[34:35], v[34:35], v[38:39]
    v_pk_add_f32 v[32:33], v[32:33], v[34:35]
    v_mul_f32 v32, 0x3b124925, v32
    v_mul_f32 v33, 0x3b124925, v33
    v_fma_f32 v33, -v32, v32, v33
    v_max_f32 v33, 0, v33
    v_cvt_pk_bf16_f32 v33, v33, v32
    v_and_b32 v34, 0xffff0000, v33
    v_lshlrev_b32 v33, 16, v33
    v_add_f32 v33, 0x3727c5ac, v33
    v_cvt_pk_bf16_f32 v33, v33, v33
    v_lshlrev_b32 v33, 16, v33
    v_sqrt_f32 v33, v33
    s_nop 0
    v_cvt_pk_bf16_f32 v33, v33, v33
    v_lshlrev_b32 v33, 16, v33
    v_rcp_f32 v35, v33
    s_nop 0
    v_sub_f32 v34, 0, v34
    v_lshlrev_b32 v10, 3, v0
    s_lshl_b32 s49, s10, 10
    buffer_store_dwordx2 v[34:35], v10, s[64:67], s49 offen sc1
    s_waitcnt vmcnt(0)
K3_ST2:
    s_barrier
    v_cmp_eq_u32 vcc, 0, v0
    s_and_saveexec_b64 s[8:9], vcc
    s_cbranch_execz K3_ST3
    s_lshl_b32 s10, s10, 2
    v_mov_b32 v1, s10
    v_mov_b32 v2, 1
    global_atomic_add v1, v2, s[60:61] sc1
K3_ST3:
    s_endpgm
.globl k4_kernel
.p2align 8
.type k4_kernel,@function
k4_kernel:
    s_cmp_ge_u32 s2, 224
    s_cbranch_scc1 K4_END
    s_load_dwordx4 s[4:7], s[0:1], 96
    s_load_dwordx2 s[8:9], s[0:1], 120
    v_lshrrev_b32 v1, 6, v0
    v_and_b32 v2, 63, v0
    s_and_b32 s10, s2, 7
    s_lshr_b32 s11, s2, 3
    v_readfirstlane_b32 s3, v1
    s_mul_i32 s12, s11, 37
    s_lshr_b32 s12, s12, 8
    s_mul_i32 s13, s12, 7
    s_sub_u32 s11, s11, s13
    s_lshl_b32 s10, s10, 2
    s_add_u32 s10, s10, s12
    s_lshr_b32 s14, s3, 1
    s_and_b32 s15, s3, 1
    v_lshlrev_b32 v3, 4, v2
    v_lshrrev_b32 v4, 3, v2
    v_bfe_u32 v5, v2, 2, 1
    v_bfe_u32 v6, v2, 4, 1
    v_xor_b32 v5, v5, v6
    v_and_b32 v6, 3, v2
    v_lshl_add_u32 v5, v5, 2, v6
    v_lshlrev_b32 v5, 4, v5
    v_mul_u32_u24 v6, 896, v4
    v_add_u32 v5, v5, v6
    v_and_b32 v6, 7, v2
    v_lshlrev_b32 v6, 4, v6
    v_mul_u32_u24 v7, 4352, v4
    v_add_u32 v6, v6, v7
    s_cmp_eq_u32 s15, 0
    s_cselect_b64 vcc, -1, 0
    v_cndmask_b32 v3, v5, v3, vcc
    s_mul_i32 s38, s14, 56
    s_mul_i32 s38, s38, 33792
    s_lshl_b32 s39, s10, 10
    s_add_u32 s38, s38, s39
    s_mul_i32 s39, s14, 401408
    s_lshl_b32 s40, s11, 7
    s_add_u32 s39, s39, s40
    s_cmp_eq_u32 s15, 0
    s_cselect_b32 s38, s38, s39
    s_movk_i32 s42, 7168
    s_cselect_b32 s39, 33792, s42
    s_lshl_b32 s40, s14, 13
    s_lshl_b32 s41, s15, 12
    s_add_u32 s41, s41, s40
    v_lshrrev_b32 v9, 4, v2
    v_bfe_u32 v10, v2, 2, 2
    v_and_b32 v11, 3, v2
    v_lshrrev_b32 v12, 1, v9
    v_lshl_add_u32 v12, v12, 3, v10
    v_lshlrev_b32 v12, 7, v12
    v_and_b32 v9, 1, v9
    v_lshl_add_u32 v12, v9, 5, v12
    v_lshl_add_u32 v12, v11, 3, v12
    v_lshrrev_b32 v13, 1, v10
    v_lshl_add_u32 v16, v13, 6, v12
    v_xor_b32 v13, 1, v13
    v_lshl_add_u32 v17, v13, 6, v12
    s_add_u32 s44, s40, 4096
    v_add_u32 v16, s44, v16
    v_add_u32 v17, s44, v17
    v_lshrrev_b32 v7, 5, v2
    v_and_b32 v15, 31, v2
    v_lshlrev_b32 v18, 4, v15
    v_lshl_add_u32 v18, v7, 10, v18
    s_lshl_b32 s44, s15, 9
    s_add_u32 s44, s44, s40
    v_add_u32 v18, s44, v18
    v_add_u32 v19, 65536, v16
    v_add_u32 v20, 65536, v17
    v_add_u32 v21, 65536, v18
    s_lshl_b32 s36, s11, 6
    s_lshl_b32 s37, s3, 3
    s_add_u32 s36, s36, s37
    s_mul_i32 s36, s36, 4352
    s_lshl_b32 s37, s10, 7
    s_add_u32 s36, s36, s37
    s_lshl_b32 s37, s3, 10
    s_add_u32 s37, s37, 131072
    s_waitcnt lgkmcnt(0)
    s_mov_b32 s16, s4
    s_mov_b32 s17, s5
    s_mov_b32 s18, 1605632
    s_mov_b32 s19, 0x00020000
    s_mov_b32 s20, s6
    s_mov_b32 s21, s7
    s_mov_b32 s22, 1835008
    s_mov_b32 s23, 0x00020000
    s_add_u32 s24, s8, 5963776
    s_addc_u32 s25, s9, 0
    s_mov_b32 s26, 1949696
    s_mov_b32 s27, 0x00020000
    s_add_u32 s32, s8, 7946240
    s_addc_u32 s33, s9, 0
    s_mov_b32 s34, 7569408
    s_mov_b32 s35, 0x00020000
    s_cmp_eq_u32 s15, 0
    s_cselect_b32 s28, s32, s16
    s_cselect_b32 s29, s33, s17
    s_cselect_b32 s30, s34, s18
    s_cselect_b32 s31, s35, s19
    s_mov_b32 m0, s37
    s_nop 0
    buffer_load_dwordx4 v6, s[24:27], s36 offen lds
    s_add_u32 s43, s41, 0
    s_mov_b32 m0, s43
    s_add_u32 s43, s43, 1024
    buffer_load_dwordx4 v3, s[28:31], s38 offen lds
    s_add_u32 s38, s38, s39
    s_mov_b32 m0, s43
    s_add_u32 s43, s43, 1024
    buffer_load_dwordx4 v3, s[28:31], s38 offen lds
    s_add_u32 s38, s38, s39
    s_mov_b32 m0, s43
    s_add_u32 s43, s43, 1024
    buffer_load_dwordx4 v3, s[28:31], s38 offen lds
    s_add_u32 s38, s38, s39
    s_mov_b32 m0, s43
    s_add_u32 s43, s43, 1024
    buffer_load_dwordx4 v3, s[28:31], s38 offen lds
    s_add_u32 s38, s38, s39
    s_add_u32 s43, s41, 32768
    s_mov_b32 m0, s43
    s_add_u32 s43, s43, 1024
    buffer_load_dwordx4 v3, s[28:31], s38 offen lds
    s_add_u32 s38, s38, s39
    s_mov_b32 m0, s43
    s_add_u32 s43, s43, 1024
    buffer_load_dwordx4 v3, s[28:31], s38 offen lds
    s_add_u32 s38, s38, s39
    s_mov_b32 m0, s43
    s_add_u32 s43, s43, 1024
    buffer_load_dwordx4 v3, s[28:31], s38 offen lds
    s_add_u32 s38, s38, s39
    s_mov_b32 m0, s43
    s_add_u32 s43, s43, 1024
    buffer_load_dwordx4 v3, s[28:31], s38 offen lds
    s_add_u32 s38, s38, s39
    s_add_u32 s43, s41, 65536
    s_mov_b32 m0, s43
    s_add_u32 s43, s43, 1024
    buffer_load_dwordx4 v3, s[28:31], s38 offen lds
    s_add_u32 s38, s38, s39
    s_mov_b32 m0, s43
    s_add_u32 s43, s43, 1024
    buffer_load_dwordx4 v3, s[28:31], s38 offen lds
    s_add_u32 s38, s38, s39
    s_mov_b32 m0, s43
    s_add_u32 s43, s43, 1024
    buffer_load_dwordx4 v3, s[28:31], s38 offen lds
    s_add_u32 s38, s38, s39
    s_mov_b32 m0, s43
    s_add_u32 s43, s43, 1024
    buffer_load_dwordx4 v3, s[28:31], s38 offen lds
    s_add_u32 s38, s38, s39
    s_cmp_ge_u32 s3, 4
    s_cselect_b64 vcc, -1, 0
    s_waitcnt vmcnt(8)
    s_barrier
    ds_read_b128 v[72:75], v18 offset:0
    ds_read_b64_tr_b16 v[64:65], v16 offset:0
    ds_read_b64_tr_b16 v[66:67], v16 offset:512
    ds_read_b64_tr_b16 v[68:69], v17 offset:0
    ds_read_b64_tr_b16 v[70:71], v17 offset:512
    s_cbranch_vccz K4_BB0
    s_waitcnt vmcnt(4)
    s_barrier
K4_BB0:
    s_waitcnt lgkmcnt(2)
    v_mfma_f32_32x32x16_bf16 v[32:47], v[64:67], v[72:75], 0
    ds_read_b128 v[88:91], v18 offset:2048
    ds_read_b64_tr_b16 v[80:81], v16 offset:2048
    ds_read_b64_tr_b16 v[82:83], v16 offset:2560
    s_waitcnt lgkmcnt(3)
    v_mfma_f32_32x32x16_bf16 v[48:63], v[68:71], v[72:75], 0
    ds_read_b64_tr_b16 v[84:85], v17 offset:2048
    ds_read_b64_tr_b16 v[86:87], v17 offset:2560
    s_cbranch_vccnz K4_BA0
    s_waitcnt vmcnt(4)
    s_barrier
K4_BA0:
    s_add_u32 s43, s41, 98304
    s_mov_b32 m0, s43
    s_add_u32 s43, s43, 1024
    buffer_load_dwordx4 v3, s[28:31], s38 offen lds
    s_add_u32 s38, s38, s39
    s_mov_b32 m0, s43
    s_add_u32 s43, s43, 1024
    buffer_load_dwordx4 v3, s[28:31], s38 offen lds
    s_add_u32 s38, s38, s39
    s_mov_b32 m0, s43
    s_add_u32 s43, s43, 1024
    buffer_load_dwordx4 v3, s[28:31], s38 offen lds
    s_add_u32 s38, s38, s39
    s_mov_b32 m0, s43
    s_add_u32 s43, s43, 1024
    buffer_load_dwordx4 v3, s[28:31], s38 offen lds
    s_add_u32 s38, s38, s39
    s_waitcnt lgkmcnt(2)
    v_mfma_f32_32x32x16_bf16 v[32:47], v[80:83], v[88:91], v[32:47]
    ds_read_b128 v[72:75], v18 offset:32768
    ds_read_b64_tr_b16 v[64:65], v16 offset:32768
    ds_read_b64_tr_b16 v[66:67], v16 offset:33280
    s_waitcnt lgkmcnt(3)
    v_mfma_f32_32x32x16_bf16 v[48:63], v[84:87], v[88:91], v[48:63]
    ds_read_b64_tr_b16 v[68:69], v17 offset:32768
    ds_read_b64_tr_b16 v[70:71], v17 offset:33280
    s_cbranch_vccz K4_BB1
    s_waitcnt vmcnt(4)
    s_barrier
K4_BB1:
    s_waitcnt lgkmcnt(2)
    v_mfma_f32_32x32x16_bf16 v[32:47], v[64:67], v[72:75], v[32:47]
    ds_read_b128 v[88:91], v18 offset:34816
    ds_read_b64_tr_b16 v[80:81], v16 offset:34816
    ds_read_b64_tr_b16 v[82:83], v16 offset:35328
    s_waitcnt lgkmcnt(3)
    v_mfma_f32_32x32x16_bf16 v[48:63], v[68:71], v[72:75], v[48:63]
    ds_read_b64_tr_b16 v[84:85], v17 offset:34816
    ds_read_b64_tr_b16 v[86:87], v17 offset:35328
    s_cbranch_vccnz K4_BA1
    s_waitcnt vmcnt(4)
    s_barrier
K4_BA1:
    s_add_u32 s43, s41, 0
    s_mov_b32 m0, s43
    s_add_u32 s43, s43, 1024
    buffer_load_dwordx4 v3, s[28:31], s38 offen lds
    s_add_u32 s38, s38, s39
    s_mov_b32 m0, s43
    s_add_u32 s43, s43, 1024
    buffer_load_dwordx4 v3, s[28:31], s38 offen lds
    s_add_u32 s38, s38, s39
    s_mov_b32 m0, s43
    s_add_u32 s43, s43, 1024
    buffer_load_dwordx4 v3, s[28:31], s38 offen lds
    s_add_u32 s38, s38, s39
    s_mov_b32 m0, s43
    s_add_u32 s43, s43, 1024
    buffer_load_dwordx4 v3, s[28:31], s38 offen lds
    s_add_u32 s38, s38, s39
    s_waitcnt lgkmcnt(2)
    v_mfma_f32_32x32x16_bf16 v[32:47], v[80:83], v[88:91], v[32:47]
    ds_read_b128 v[72:75], v21 offset:0
    ds_read_b64_tr_b16 v[64:65], v19 offset:0
    ds_read_b64_tr_b16 v[66:67], v19 offset:512
    s_waitcnt lgkmcnt(3)
    v_mfma_f32_32x32x16_bf16 v[48:63], v[84:87], v[88:91], v[48:63]
    ds_read_b64_tr_b16 v[68:69], v20 offset:0
    ds_read_b64_tr_b16 v[70:71], v20 offset:512
    s_cbranch_vccz K4_BB2
    s_waitcnt vmcnt(4)
    s_barrier
K4_BB2:
    s_waitcnt lgkmcnt(2)
    v_mfma_f32_32x32x16_bf16 v[32:47], v[64:67], v[72:75], v[32:47]
    ds_read_b128 v[88:91], v21 offset:2048
    ds_read_b64_tr_b16 v[80:81], v19 offset:2048
    ds_read_b64_tr_b16 v[82:83], v19 offset:2560
    s_waitcnt lgkmcnt(3)
    v_mfma_f32_32x32x16_bf16 v[48:63], v[68:71], v[72:75], v[48:63]
    ds_read_b64_tr_b16 v[84:85], v20 offset:2048
    ds_read_b64_tr_b16 v[86:87], v20 offset:2560
    s_cbranch_vccnz K4_BA2
    s_waitcnt vmcnt(4)
    s_barrier
K4_BA2:
    s_add_u32 s43, s41, 32768
    s_mov_b32 m0, s43
    s_add_u32 s43, s43, 1024
    buffer_load_dwordx4 v3, s[28:31], s38 offen lds
    s_add_u32 s38, s38, s39
    s_mov_b32 m0, s43
    s_add_u32 s43, s43, 1024
    buffer_load_dwordx4 v3, s[28:31], s38 offen lds
    s_add_u32 s38, s38, s39
    s_mov_b32 m0, s43
    s_add_u32 s43, s43, 1024
    buffer_load_dwordx4 v3, s[28:31], s38 offen lds
    s_add_u32 s38, s38, s39
    s_mov_b32 m0, s43
    s_add_u32 s43, s43, 1024
    buffer_load_dwordx4 v3, s[28:31], s38 offen lds
    s_add_u32 s38, s38, s39
    s_waitcnt lgkmcnt(2)
    v_mfma_f32_32x32x16_bf16 v[32:47], v[80:83], v[88:91], v[32:47]
    ds_read_b128 v[72:75], v21 offset:32768
    ds_read_b64_tr_b16 v[64:65], v19 offset:32768
    ds_read_b64_tr_b16 v[66:67], v19 offset:33280
    s_waitcnt lgkmcnt(3)
    v_mfma_f32_32x32x16_bf16 v[48:63], v[84:87], v[88:91], v[48:63]
    ds_read_b64_tr_b16 v[68:69], v20 offset:32768
    ds_read_b64_tr_b16 v[70:71], v20 offset:33280
    s_cbranch_vccz K4_BB3
    s_waitcnt vmcnt(4)
    s_barrier
K4_BB3:
    s_waitcnt lgkmcnt(2)
    v_mfma_f32_32x32x16_bf16 v[32:47], v[64:67], v[72:75], v[32:47]
    ds_read_b128 v[88:91], v21 offset:34816
    ds_read_b64_tr_b16 v[80:81], v19 offset:34816
    ds_read_b64_tr_b16 v[82:83], v19 offset:35328
    s_waitcnt lgkmcnt(3)
    v_mfma_f32_32x32x16_bf16 v[48:63], v[68:71], v[72:75], v[48:63]
    ds_read_b64_tr_b16 v[84:85], v20 offset:34816
    ds_read_b64_tr_b16 v[86:87], v20 offset:35328
    s_cbranch_vccnz K4_BA3
    s_waitcnt vmcnt(4)
    s_barrier
K4_BA3:
    s_add_u32 s43, s41, 65536
    s_mov_b32 m0, s43
    s_add_u32 s43, s43, 1024
    buffer_load_dwordx4 v3, s[28:31], s38 offen lds
    s_add_u32 s38, s38, s39
    s_mov_b32 m0, s43
    s_add_u32 s43, s43, 1024
    buffer_load_dwordx4 v3, s[28:31], s38 offen lds
    s_add_u32 s38, s38, s39
    s_mov_b32 m0, s43
    s_add_u32 s43, s43, 1024
    buffer_load_dwordx4 v3, s[28:31], s38 offen lds
    s_add_u32 s38, s38, s39
    s_mov_b32 m0, s43
    s_add_u32 s43, s43, 1024
    buffer_load_dwordx4 v3, s[28:31], s38 offen lds
    s_add_u32 s38, s38, s39
    s_waitcnt lgkmcnt(2)
    v_mfma_f32_32x32x16_bf16 v[32:47], v[80:83], v[88:91], v[32:47]
    ds_read_b128 v[72:75], v18 offset:0
    ds_read_b64_tr_b16 v[64:65], v16 offset:0
    ds_read_b64_tr_b16 v[66:67], v16 offset:512
    s_waitcnt lgkmcnt(3)
    v_mfma_f32_32x32x16_bf16 v[48:63], v[84:87], v[88:91], v[48:63]
    ds_read_b64_tr_b16 v[68:69], v17 offset:0
    ds_read_b64_tr_b16 v[70:71], v17 offset:512
    s_cbranch_vccz K4_BB4
    s_waitcnt vmcnt(4)
    s_barrier
K4_BB4:
    s_waitcnt lgkmcnt(2)
    v_mfma_f32_32x32x16_bf16 v[32:47], v[64:67], v[72:75], v[32:47]
    ds_read_b128 v[88:91], v18 offset:2048
    ds_read_b64_tr_b16 v[80:81], v16 offset:2048
    ds_read_b64_tr_b16 v[82:83], v16 offset:2560
    s_waitcnt lgkmcnt(3)
    v_mfma_f32_32x32x16_bf16 v[48:63], v[68:71], v[72:75], v[48:63]
    ds_read_b64_tr_b16 v[84:85], v17 offset:2048
    ds_read_b64_tr_b16 v[86:87], v17 offset:2560
    s_cbranch_vccnz K4_BA4
    s_waitcnt vmcnt(4)
    s_barrier
K4_BA4:
    s_add_u32 s43, s41, 98304
    s_mov_b32 m0, s43
    s_add_u32 s43, s43, 1024
    buffer_load_dwordx4 v3, s[28:31], s38 offen lds
    s_add_u32 s38, s38, s39
    s_mov_b32 m0, s43
    s_add_u32 s43, s43, 1024
    buffer_load_dwordx4 v3, s[28:31], s38 offen lds
    s_add_u32 s38, s38, s39
    s_mov_b32 m0, s43
    s_add_u32 s43, s43, 1024
    buffer_load_dwordx4 v3, s[28:31], s38 offen lds
    s_add_u32 s38, s38, s39
    s_mov_b32 m0, s43
    s_add_u32 s43, s43, 1024
    buffer_load_dwordx4 v3, s[28:31], s38 offen lds
    s_add_u32 s38, s38, s39
    s_waitcnt lgkmcnt(2)
    v_mfma_f32_32x32x16_bf16 v[32:47], v[80:83], v[88:91], v[32:47]
    ds_read_b128 v[72:75], v18 offset:32768
    ds_read_b64_tr_b16 v[64:65], v16 offset:32768
    ds_read_b64_tr_b16 v[66:67], v16 offset:33280
    s_waitcnt lgkmcnt(3)
    v_mfma_f32_32x32x16_bf16 v[48:63], v[84:87], v[88:91], v[48:63]
    ds_read_b64_tr_b16 v[68:69], v17 offset:32768
    ds_read_b64_tr_b16 v[70:71], v17 offset:33280
    s_cbranch_vccz K4_BB5
    s_waitcnt vmcnt(4)
    s_barrier
K4_BB5:
    s_waitcnt lgkmcnt(2)
    v_mfma_f32_32x32x16_bf16 v[32:47], v[64:67], v[72:75], v[32:47]
    ds_read_b128 v[88:91], v18 offset:34816
    ds_read_b64_tr_b16 v[80:81], v16 offset:34816
    ds_read_b64_tr_b16 v[82:83], v16 offset:35328
    s_waitcnt lgkmcnt(3)
    v_mfma_f32_32x32x16_bf16 v[48:63], v[68:71], v[72:75], v[48:63]
    ds_read_b64_tr_b16 v[84:85], v17 offset:34816
    ds_read_b64_tr_b16 v[86:87], v17 offset:35328
    s_cbranch_vccnz K4_BA5
    s_waitcnt vmcnt(4)
    s_barrier
K4_BA5:
    s_add_u32 s43, s41, 0
    s_mov_b32 m0, s43
    s_add_u32 s43, s43, 1024
    buffer_load_dwordx4 v3, s[28:31], s38 offen lds
    s_add_u32 s38, s38, s39
    s_mov_b32 m0, s43
    s_add_u32 s43, s43, 1024
    buffer_load_dwordx4 v3, s[28:31], s38 offen lds
    s_add_u32 s38, s38, s39
    s_mov_b32 m0, s43
    s_add_u32 s43, s43, 1024
    buffer_load_dwordx4 v3, s[28:31], s38 offen lds
    s_add_u32 s38, s38, s39
    s_mov_b32 m0, s43
    s_add_u32 s43, s43, 1024
    buffer_load_dwordx4 v3, s[28:31], s38 offen lds
    s_add_u32 s38, s38, s39
    s_waitcnt lgkmcnt(2)
    v_mfma_f32_32x32x16_bf16 v[32:47], v[80:83], v[88:91], v[32:47]
    ds_read_b128 v[72:75], v21 offset:0
    ds_read_b64_tr_b16 v[64:65], v19 offset:0
    ds_read_b64_tr_b16 v[66:67], v19 offset:512
    s_waitcnt lgkmcnt(3)
    v_mfma_f32_32x32x16_bf16 v[48:63], v[84:87], v[88:91], v[48:63]
    ds_read_b64_tr_b16 v[68:69], v20 offset:0
    ds_read_b64_tr_b16 v[70:71], v20 offset:512
    s_cbranch_vccz K4_BB6
    s_waitcnt vmcnt(4)
    s_barrier
K4_BB6:
    s_waitcnt lgkmcnt(2)
    v_mfma_f32_32x32x16_bf16 v[32:47], v[64:67], v[72:75], v[32:47]
    ds_read_b128 v[88:91], v21 offset:2048
    ds_read_b64_tr_b16 v[80:81], v19 offset:2048
    ds_read_b64_tr_b16 v[82:83], v19 offset:2560
    s_waitcnt lgkmcnt(3)
    v_mfma_f32_32x32x16_bf16 v[48:63], v[68:71], v[72:75], v[48:63]
    ds_read_b64_tr_b16 v[84:85], v20 offset:2048
    ds_read_b64_tr_b16 v[86:87], v20 offset:2560
    s_cbranch_vccnz K4_BA6
    s_waitcnt vmcnt(4)
    s_barrier
K4_BA6:
    s_add_u32 s43, s41, 32768
    s_mov_b32 m0, s43
    s_add_u32 s43, s43, 1024
    buffer_load_dwordx4 v3, s[28:31], s38 offen lds
    s_add_u32 s38, s38, s39
    s_mov_b32 m0, s43
    s_add_u32 s43, s43, 1024
    buffer_load_dwordx4 v3, s[28:31], s38 offen lds
    s_add_u32 s38, s38, s39
    s_mov_b32 m0, s43
    s_add_u32 s43, s43, 1024
    buffer_load_dwordx4 v3, s[28:31], s38 offen lds
    s_add_u32 s38, s38, s39
    s_mov_b32 m0, s43
    s_add_u32 s43, s43, 1024
    buffer_load_dwordx4 v3, s[28:31], s38 offen lds
    s_add_u32 s38, s38, s39
    s_waitcnt lgkmcnt(2)
    v_mfma_f32_32x32x16_bf16 v[32:47], v[80:83], v[88:91], v[32:47]
    ds_read_b128 v[72:75], v21 offset:32768
    ds_read_b64_tr_b16 v[64:65], v19 offset:32768
    ds_read_b64_tr_b16 v[66:67], v19 offset:33280
    s_waitcnt lgkmcnt(3)
    v_mfma_f32_32x32x16_bf16 v[48:63], v[84:87], v[88:91], v[48:63]
    ds_read_b64_tr_b16 v[68:69], v20 offset:32768
    ds_read_b64_tr_b16 v[70:71], v20 offset:33280
    s_cbranch_vccz K4_BB7
    s_waitcnt vmcnt(4)
    s_barrier
K4_BB7:
    s_waitcnt lgkmcnt(2)
    v_mfma_f32_32x32x16_bf16 v[32:47], v[64:67], v[72:75], v[32:47]
    ds_read_b128 v[88:91], v21 offset:34816
    ds_read_b64_tr_b16 v[80:81], v19 offset:34816
    ds_read_b64_tr_b16 v[82:83], v19 offset:35328
    s_waitcnt lgkmcnt(3)
    v_mfma_f32_32x32x16_bf16 v[48:63], v[68:71], v[72:75], v[48:63]
    ds_read_b64_tr_b16 v[84:85], v20 offset:34816
    ds_read_b64_tr_b16 v[86:87], v20 offset:35328
    s_cbranch_vccnz K4_BA7
    s_waitcnt vmcnt(4)
    s_barrier
K4_BA7:
    s_add_u32 s43, s41, 65536
    s_mov_b32 m0, s43
    s_add_u32 s43, s43, 1024
    buffer_load_dwordx4 v3, s[28:31], s38 offen lds
    s_add_u32 s38, s38, s39
    s_mov_b32 m0, s43
    s_add_u32 s43, s43, 1024
    buffer_load_dwordx4 v3, s[28:31], s38 offen lds
    s_add_u32 s38, s38, s39
    s_mov_b32 m0, s43
    s_add_u32 s43, s43, 1024
    buffer_load_dwordx4 v3, s[28:31], s38 offen lds
    s_add_u32 s38, s38, s39
    s_mov_b32 m0, s43
    s_add_u32 s43, s43, 1024
    buffer_load_dwordx4 v3, s[28:31], s38 offen lds
    s_add_u32 s38, s38, s39
    s_waitcnt lgkmcnt(2)
    v_mfma_f32_32x32x16_bf16 v[32:47], v[80:83], v[88:91], v[32:47]
    ds_read_b128 v[72:75], v18 offset:0
    ds_read_b64_tr_b16 v[64:65], v16 offset:0
    ds_read_b64_tr_b16 v[66:67], v16 offset:512
    s_waitcnt lgkmcnt(3)
    v_mfma_f32_32x32x16_bf16 v[48:63], v[84:87], v[88:91], v[48:63]
    ds_read_b64_tr_b16 v[68:69], v17 offset:0
    ds_read_b64_tr_b16 v[70:71], v17 offset:512
    s_cbranch_vccz K4_BB8
    s_waitcnt vmcnt(4)
    s_barrier
K4_BB8:
    s_waitcnt lgkmcnt(2)
    v_mfma_f32_32x32x16_bf16 v[32:47], v[64:67], v[72:75], v[32:47]
    ds_read_b128 v[88:91], v18 offset:2048
    ds_read_b64_tr_b16 v[80:81], v16 offset:2048
    ds_read_b64_tr_b16 v[82:83], v16 offset:2560
    s_waitcnt lgkmcnt(3)
    v_mfma_f32_32x32x16_bf16 v[48:63], v[68:71], v[72:75], v[48:63]
    ds_read_b64_tr_b16 v[84:85], v17 offset:2048
    ds_read_b64_tr_b16 v[86:87], v17 offset:2560
    s_cbranch_vccnz K4_BA8
    s_waitcnt vmcnt(4)
    s_barrier
K4_BA8:
    s_add_u32 s43, s41, 98304
    s_mov_b32 m0, s43
    s_add_u32 s43, s43, 1024
    buffer_load_dwordx4 v3, s[28:31], s38 offen lds
    s_add_u32 s38, s38, s39
    s_mov_b32 m0, s43
    s_add_u32 s43, s43, 1024
    buffer_load_dwordx4 v3, s[28:31], s38 offen lds
    s_add_u32 s38, s38, s39
    s_mov_b32 m0, s43
    s_add_u32 s43, s43, 1024
    buffer_load_dwordx4 v3, s[28:31], s38 offen lds
    s_add_u32 s38, s38, s39
    s_mov_b32 m0, s43
    s_add_u32 s43, s43, 1024
    buffer_load_dwordx4 v3, s[28:31], s38 offen lds
    s_add_u32 s38, s38, s39
    s_waitcnt lgkmcnt(2)
    v_mfma_f32_32x32x16_bf16 v[32:47], v[80:83], v[88:91], v[32:47]
    ds_read_b128 v[72:75], v18 offset:32768
    ds_read_b64_tr_b16 v[64:65], v16 offset:32768
    ds_read_b64_tr_b16 v[66:67], v16 offset:33280
    s_waitcnt lgkmcnt(3)
    v_mfma_f32_32x32x16_bf16 v[48:63], v[84:87], v[88:91], v[48:63]
    ds_read_b64_tr_b16 v[68:69], v17 offset:32768
    ds_read_b64_tr_b16 v[70:71], v17 offset:33280
    s_cbranch_vccz K4_BB9
    s_waitcnt vmcnt(4)
    s_barrier
K4_BB9:
    s_waitcnt lgkmcnt(2)
    v_mfma_f32_32x32x16_bf16 v[32:47], v[64:67], v[72:75], v[32:47]
    ds_read_b128 v[88:91], v18 offset:34816
    ds_read_b64_tr_b16 v[80:81], v16 offset:34816
    ds_read_b64_tr_b16 v[82:83], v16 offset:35328
    s_waitcnt lgkmcnt(3)
    v_mfma_f32_32x32x16_bf16 v[48:63], v[68:71], v[72:75], v[48:63]
    ds_read_b64_tr_b16 v[84:85], v17 offset:34816
    ds_read_b64_tr_b16 v[86:87], v17 offset:35328
    s_cbranch_vccnz K4_BA9
    s_waitcnt vmcnt(4)
    s_barrier
K4_BA9:
    s_add_u32 s43, s41, 0
    s_mov_b32 m0, s43
    s_add_u32 s43, s43, 1024
    buffer_load_dwordx4 v3, s[28:31], s38 offen lds
    s_add_u32 s38, s38, s39
    s_mov_b32 m0, s43
    s_add_u32 s43, s43, 1024
    buffer_load_dwordx4 v3, s[28:31], s38 offen lds
    s_add_u32 s38, s38, s39
    s_mov_b32 m0, s43
    s_add_u32 s43, s43, 1024
    buffer_load_dwordx4 v3, s[28:31], s38 offen lds
    s_add_u32 s38, s38, s39
    s_mov_b32 m0, s43
    s_add_u32 s43, s43, 1024
    buffer_load_dwordx4 v3, s[28:31], s38 offen lds
    s_add_u32 s38, s38, s39
    s_waitcnt lgkmcnt(2)
    v_mfma_f32_32x32x16_bf16 v[32:47], v[80:83], v[88:91], v[32:47]
    ds_read_b128 v[72:75], v21 offset:0
    ds_read_b64_tr_b16 v[64:65], v19 offset:0
    ds_read_b64_tr_b16 v[66:67], v19 offset:512
    s_waitcnt lgkmcnt(3)
    v_mfma_f32_32x32x16_bf16 v[48:63], v[84:87], v[88:91], v[48:63]
    ds_read_b64_tr_b16 v[68:69], v20 offset:0
    ds_read_b64_tr_b16 v[70:71], v20 offset:512
    s_cbranch_vccz K4_BB10
    s_waitcnt vmcnt(4)
    s_barrier
K4_BB10:
    s_waitcnt lgkmcnt(2)
    v_mfma_f32_32x32x16_bf16 v[32:47], v[64:67], v[72:75], v[32:47]
    ds_read_b128 v[88:91], v21 offset:2048
    ds_read_b64_tr_b16 v[80:81], v19 offset:2048
    ds_read_b64_tr_b16 v[82:83], v19 offset:2560
    s_waitcnt lgkmcnt(3)
    v_mfma_f32_32x32x16_bf16 v[48:63], v[68:71], v[72:75], v[48:63]
    ds_read_b64_tr_b16 v[84:85], v20 offset:2048
    ds_read_b64_tr_b16 v[86:87], v20 offset:2560
    s_cbranch_vccnz K4_BA10
    s_waitcnt vmcnt(4)
    s_barrier
K4_BA10:
    s_add_u32 s43, s41, 32768
    s_mov_b32 m0, s43
    s_add_u32 s43, s43, 1024
    buffer_load_dwordx4 v3, s[28:31], s38 offen lds
    s_add_u32 s38, s38, s39
    s_mov_b32 m0, s43
    s_add_u32 s43, s43, 1024
    buffer_load_dwordx4 v3, s[28:31], s38 offen lds
    s_add_u32 s38, s38, s39
    s_mov_b32 m0, s43
    s_add_u32 s43, s43, 1024
    buffer_load_dwordx4 v3, s[28:31], s38 offen lds
    s_add_u32 s38, s38, s39
    s_mov_b32 m0, s43
    s_add_u32 s43, s43, 1024
    buffer_load_dwordx4 v3, s[28:31], s38 offen lds
    s_add_u32 s38, s38, s39
    s_waitcnt lgkmcnt(2)
    v_mfma_f32_32x32x16_bf16 v[32:47], v[80:83], v[88:91], v[32:47]
    ds_read_b128 v[72:75], v21 offset:32768
    ds_read_b64_tr_b16 v[64:65], v19 offset:32768
    ds_read_b64_tr_b16 v[66:67], v19 offset:33280
    s_waitcnt lgkmcnt(3)
    v_mfma_f32_32x32x16_bf16 v[48:63], v[84:87], v[88:91], v[48:63]
    ds_read_b64_tr_b16 v[68:69], v20 offset:32768
    ds_read_b64_tr_b16 v[70:71], v20 offset:33280
    s_cbranch_vccz K4_BB11
    s_waitcnt vmcnt(4)
    s_barrier
K4_BB11:
    s_waitcnt lgkmcnt(2)
    v_mfma_f32_32x32x16_bf16 v[32:47], v[64:67], v[72:75], v[32:47]
    ds_read_b128 v[88:91], v21 offset:34816
    ds_read_b64_tr_b16 v[80:81], v19 offset:34816
    ds_read_b64_tr_b16 v[82:83], v19 offset:35328
    s_waitcnt lgkmcnt(3)
    v_mfma_f32_32x32x16_bf16 v[48:63], v[68:71], v[72:75], v[48:63]
    ds_read_b64_tr_b16 v[84:85], v20 offset:34816
    ds_read_b64_tr_b16 v[86:87], v20 offset:35328
    s_cbranch_vccnz K4_BA11
    s_waitcnt vmcnt(4)
    s_barrier
K4_BA11:
    s_waitcnt lgkmcnt(2)
    v_mfma_f32_32x32x16_bf16 v[32:47], v[80:83], v[88:91], v[32:47]
    ds_read_b128 v[72:75], v18 offset:0
    ds_read_b64_tr_b16 v[64:65], v16 offset:0
    ds_read_b64_tr_b16 v[66:67], v16 offset:512
    s_waitcnt lgkmcnt(3)
    v_mfma_f32_32x32x16_bf16 v[48:63], v[84:87], v[88:91], v[48:63]
    ds_read_b64_tr_b16 v[68:69], v17 offset:0
    ds_read_b64_tr_b16 v[70:71], v17 offset:512
    s_cbranch_vccz K4_BB12
    s_waitcnt vmcnt(0)
    s_barrier
K4_BB12:
    s_waitcnt lgkmcnt(2)
    v_mfma_f32_32x32x16_bf16 v[32:47], v[64:67], v[72:75], v[32:47]
    ds_read_b128 v[88:91], v18 offset:2048
    ds_read_b64_tr_b16 v[80:81], v16 offset:2048
    ds_read_b64_tr_b16 v[82:83], v16 offset:2560
    s_waitcnt lgkmcnt(3)
    v_mfma_f32_32x32x16_bf16 v[48:63], v[68:71], v[72:75], v[48:63]
    ds_read_b64_tr_b16 v[84:85], v17 offset:2048
    ds_read_b64_tr_b16 v[86:87], v17 offset:2560
    s_cbranch_vccnz K4_BA12
    s_waitcnt vmcnt(0)
    s_barrier
K4_BA12:
    s_waitcnt lgkmcnt(2)
    v_mfma_f32_32x32x16_bf16 v[32:47], v[80:83], v[88:91], v[32:47]
    ds_read_b128 v[72:75], v18 offset:32768
    ds_read_b64_tr_b16 v[64:65], v16 offset:32768
    ds_read_b64_tr_b16 v[66:67], v16 offset:33280
    s_waitcnt lgkmcnt(3)
    v_mfma_f32_32x32x16_bf16 v[48:63], v[84:87], v[88:91], v[48:63]
    ds_read_b64_tr_b16 v[68:69], v17 offset:32768
    ds_read_b64_tr_b16 v[70:71], v17 offset:33280
    s_waitcnt lgkmcnt(2)
    v_mfma_f32_32x32x16_bf16 v[32:47], v[64:67], v[72:75], v[32:47]
    ds_read_b128 v[88:91], v18 offset:34816
    ds_read_b64_tr_b16 v[80:81], v16 offset:34816
    ds_read_b64_tr_b16 v[82:83], v16 offset:35328
    s_waitcnt lgkmcnt(3)
    v_mfma_f32_32x32x16_bf16 v[48:63], v[68:71], v[72:75], v[48:63]
    ds_read_b64_tr_b16 v[84:85], v17 offset:34816
    ds_read_b64_tr_b16 v[86:87], v17 offset:35328
    s_waitcnt lgkmcnt(2)
    v_mfma_f32_32x32x16_bf16 v[32:47], v[80:83], v[88:91], v[32:47]
    s_waitcnt lgkmcnt(0)
    v_mfma_f32_32x32x16_bf16 v[48:63], v[84:87], v[88:91], v[48:63]
    v_lshrrev_b32 v21, 3, v0
    v_and_b32 v22, 7, v0
    v_mul_u32_u24 v23, 272, v21
    v_lshl_add_u32 v23, v22, 5, v23
    v_lshlrev_b32 v25, 10, v22
    v_lshl_add_u32 v25, v21, 1, v25
    v_add_u32 v25, 131072, v25
    v_mul_u32_u24 v26, 896, v21
    v_lshl_add_u32 v26, v22, 4, v26
    s_mul_i32 s45, s10, 57344
    s_lshl_b32 s46, s11, 7
    s_add_u32 s45, s45, s46
    ds_read_u16 v96, v25 offset:0
    ds_read_u16 v97, v25 offset:128
    ds_read_u16 v98, v25 offset:256
    ds_read_u16 v99, v25 offset:384
    ds_read_u16 v100, v25 offset:512
    ds_read_u16 v101, v25 offset:640
    ds_read_u16 v102, v25 offset:768
    ds_read_u16 v103, v25 offset:896
    v_mul_u32_u24 v20, 272, v15
    v_lshl_add_u32 v20, v7, 4, v20
    s_mul_i32 s44, s14, 17408
    s_mul_i32 s47, s15, 8704
    s_add_u32 s44, s44, s47
    v_add_u32 v20, s44, v20
    s_barrier
    s_nop 3
    ds_write_b128 v20, v[32:35] offset:0
    ds_write_b128 v20, v[36:39] offset:32
    ds_write_b128 v20, v[40:43] offset:64
    ds_write_b128 v20, v[44:47] offset:96
    ds_write_b128 v20, v[48:51] offset:128
    ds_write_b128 v20, v[52:55] offset:160
    ds_write_b128 v20, v[56:59] offset:192
    ds_write_b128 v20, v[60:63] offset:224
    s_waitcnt lgkmcnt(0)
    s_barrier
    ds_read_b128 v[32:35], v23 offset:0
    ds_read_b128 v[36:39], v23 offset:16
    ds_read_b128 v[40:43], v23 offset:17408
    ds_read_b128 v[44:47], v23 offset:17424
    ds_read_b128 v[48:51], v23 offset:34816
    ds_read_b128 v[52:55], v23 offset:34832
    ds_read_b128 v[56:59], v23 offset:52224
    ds_read_b128 v[60:63], v23 offset:52240
    v_lshlrev_b32 v96, 16, v96
    v_lshlrev_b32 v97, 16, v97
    v_lshlrev_b32 v98, 16, v98
    v_lshlrev_b32 v99, 16, v99
    v_lshlrev_b32 v100, 16, v100
    v_lshlrev_b32 v101, 16, v101
    v_lshlrev_b32 v102, 16, v102
    v_lshlrev_b32 v103, 16, v103
    s_waitcnt lgkmcnt(0)
    v_pk_add_f32 v[32:33], v[32:33], v[40:41]
    v_pk_add_f32 v[48:49], v[48:49], v[56:57]
    v_pk_add_f32 v[32:33], v[32:33], v[48:49]
    v_cvt_pk_bf16_f32 v104, v32, v33
    v_lshlrev_b32 v32, 16, v104
    v_and_b32 v33, 0xffff0000, v104
    v_pk_add_f32 v[32:33], v[32:33], v[96:97]
    v_cvt_pk_bf16_f32 v108, v32, v33
    v_pk_add_f32 v[34:35], v[34:35], v[42:43]
    v_pk_add_f32 v[50:51], v[50:51], v[58:59]
    v_pk_add_f32 v[34:35], v[34:35], v[50:51]
    v_cvt_pk_bf16_f32 v104, v34, v35
    v_lshlrev_b32 v34, 16, v104
    v_and_b32 v35, 0xffff0000, v104
    v_pk_add_f32 v[34:35], v[34:35], v[98:99]
    v_cvt_pk_bf16_f32 v109, v34, v35
    v_pk_add_f32 v[36:37], v[36:37], v[44:45]
    v_pk_add_f32 v[52:53], v[52:53], v[60:61]
    v_pk_add_f32 v[36:37], v[36:37], v[52:53]
    v_cvt_pk_bf16_f32 v104, v36, v37
    v_lshlrev_b32 v36, 16, v104
    v_and_b32 v37, 0xffff0000, v104
    v_pk_add_f32 v[36:37], v[36:37], v[100:101]
    v_cvt_pk_bf16_f32 v110, v36, v37
    v_pk_add_f32 v[38:39], v[38:39], v[46:47]
    v_pk_add_f32 v[54:55], v[54:55], v[62:63]
    v_pk_add_f32 v[38:39], v[38:39], v[54:55]
    v_cvt_pk_bf16_f32 v104, v38, v39
    v_lshlrev_b32 v38, 16, v104
    v_and_b32 v39, 0xffff0000, v104
    v_pk_add_f32 v[38:39], v[38:39], v[102:103]
    v_cvt_pk_bf16_f32 v111, v38, v39
    buffer_store_dwordx4 v[108:111], v26, s[20:23], s45 offen sc1
K4_END:
    s_endpgm
.section .rodata,"a"
.p2align 6
.amdhsa_kernel k1_kernel
  .amdhsa_next_free_vgpr 200
  .amdhsa_next_free_sgpr 102
  .amdhsa_accum_offset 200
  .amdhsa_group_segment_fixed_size 0
  .amdhsa_kernarg_size 128
  .amdhsa_user_sgpr_count 2
  .amdhsa_user_sgpr_kernarg_segment_ptr 1
  .amdhsa_system_sgpr_workgroup_id_x 1
.end_amdhsa_kernel
.p2align 6
.amdhsa_kernel k2_kernel
  .amdhsa_next_free_vgpr 152
  .amdhsa_next_free_sgpr 102
  .amdhsa_accum_offset 152
  .amdhsa_group_segment_fixed_size 0
  .amdhsa_kernarg_size 128
  .amdhsa_user_sgpr_count 2
  .amdhsa_user_sgpr_kernarg_segment_ptr 1
  .amdhsa_system_sgpr_workgroup_id_x 1
.end_amdhsa_kernel
.p2align 6
.amdhsa_kernel k3_kernel
  .amdhsa_next_free_vgpr 232
  .amdhsa_next_free_sgpr 102
  .amdhsa_accum_offset 232
  .amdhsa_group_segment_fixed_size 0
  .amdhsa_kernarg_size 128
  .amdhsa_user_sgpr_count 2
  .amdhsa_user_sgpr_kernarg_segment_ptr 1
  .amdhsa_system_sgpr_workgroup_id_x 1
.end_amdhsa_kernel
.p2align 6
.amdhsa_kernel k4_kernel
  .amdhsa_next_free_vgpr 128
  .amdhsa_next_free_sgpr 102
  .amdhsa_accum_offset 128
  .amdhsa_group_segment_fixed_size 0
  .amdhsa_kernarg_size 128
  .amdhsa_user_sgpr_count 2
  .amdhsa_user_sgpr_kernarg_segment_ptr 1
  .amdhsa_system_sgpr_workgroup_id_x 1
.end_amdhsa_kernel
```
